```python
import torch

def _softmax(x, axis=-1):
    return torch.softmax(x, dim=axis)
def _gelu(x):
    return torch.nn.functional.gelu(x, approximate="tanh")
def _silu(x):
    return torch.nn.functional.silu(x)
def _sigmoid(x):
    return torch.sigmoid(x)
def _layernorm(x, axis=-1, eps=1e-5):
    m = x.mean(dim=axis, keepdim=True)
    v = x.var(dim=axis, keepdim=True, unbiased=False)
    return (x - m) / torch.sqrt(v + eps)
def _scatter_add(tgt, idx, src, axis=0):
    return tgt.clone().index_add_(axis, idx, src)
def _segment_sum(src, seg, n):
    out = torch.zeros((n,) + src.shape[1:], dtype=src.dtype)
    return out.index_add_(0, seg, src)
def _pad(x, pw):
    flat = tuple(v for pair in reversed(pw) for v in pair)
    return torch.nn.functional.pad(x, flat)

kernel_name = 'sequential_preLN__spectral_fnet__moe_arch_mod__prompt'

def setup_inputs():

    _w = (lambda a: (lambda t: t.to(torch.bfloat16) if t.is_floating_point() else t)(torch.as_tensor(a)))
    def _A_setup():
        B, S, D = 1, 2048, 448
        ns = torch.arange(S)[:, None] * torch.arange(S)[None, :]
        nd = torch.arange(D)[:, None] * torch.arange(D)[None, :]
        Ws_re = torch.cos(-2.0 * torch.pi * ns / S).to(float)
        Ws_im = torch.sin(-2.0 * torch.pi * ns / S).to(float)
        Wd_re = torch.cos(-2.0 * torch.pi * nd / D).to(float)
        Wd_im = torch.sin(-2.0 * torch.pi * nd / D).to(float)
        return {
            "x": _w((lambda *s: torch.randn(*s, dtype=torch.bfloat16) * 0.05)(B, S, D)),
            "dft_seq_re": _w(Ws_re),
            "dft_seq_im": _w(Ws_im),
            "dft_hid_re": _w(Wd_re),
            "dft_hid_im": _w(Wd_im),
        }
    _A_in = _A_setup()

    def _B_setup():
        B, S, D, F, C = 1, 2048, 448, 1792, 8
        return {
            "x": _w((lambda *s: torch.randn(*s, dtype=torch.bfloat16) * 0.05)(B, S, D)),
            "w_r": _w((lambda *s: torch.randn(*s, dtype=torch.bfloat16) * 1.6)(D)),
            "w_gate": _w((lambda *s: torch.randn(*s, dtype=torch.bfloat16) * 0.4)(D, F)),
            "w_up": _w((lambda *s: torch.randn(*s, dtype=torch.bfloat16) * 0.4)(D, F)),
            "w_down": _w((lambda *s: torch.randn(*s, dtype=torch.bfloat16) * 0.4)(F, D)),
        }
    _B_in = _B_setup()

    return {
        "A_x": _A_in["x"],
        "A_dft_seq_re": _A_in["dft_seq_re"],
        "A_dft_seq_im": _A_in["dft_seq_im"],
        "A_dft_hid_re": _A_in["dft_hid_re"],
        "A_dft_hid_im": _A_in["dft_hid_im"],
        "B_x": _B_in["x"],
        "B_w_r": _B_in["w_r"],
        "B_w_gate": _B_in["w_gate"],
        "B_w_up": _B_in["w_up"],
        "B_w_down": _B_in["w_down"],
    }

def reference(A_x, A_dft_seq_re, A_dft_seq_im, A_dft_hid_re, A_dft_hid_im, B_x, B_w_r, B_w_gate, B_w_up, B_w_down):
    def _A_ref(x, dft_seq_re, dft_seq_im, dft_hid_re, dft_hid_im):
        a = torch.einsum("bsd,ed->bse", x, dft_hid_re)
        b = torch.einsum("bsd,ed->bse", x, dft_hid_im)
        y = torch.einsum("ts,bse->bte", dft_seq_re, a) - torch.einsum("ts,bse->bte", dft_seq_im, b)
        return y

    def _B_ref(x, w_r, w_gate, w_up, w_down):
        B, S, D = x.shape
        C = 8
        r = x @ w_r
        idx = torch.argsort(-r, axis=-1)[:, :C]
        idx_e = (lambda x, n, axis: torch.repeat_interleave(x, n, dim=axis))(idx.reshape(B, C, 1), D, axis=2)
        x_sel = (lambda x, i, axis: torch.take_along_dim(x, i, dim=axis))(x, idx_e, axis=1)
        g = _silu(x_sel @ w_gate)
        u = x_sel @ w_up
        y = (g * u) @ w_down
        r_sel = _sigmoid((lambda x, i, axis: torch.take_along_dim(x, i, dim=axis))(r, idx, axis=1))
        y = y * r_sel.reshape(B, C, 1)
        b_off = (torch.arange(B) * S).reshape(B, 1)
        flat_idx = (idx + b_off).reshape(B * C)
        zero = (x * 0.0).reshape(B * S, D)
        upd = _scatter_add(zero, flat_idx, y.reshape(B * C, D), axis=0)
        return x + upd.reshape(B, S, D)

    x = A_x
    h = x + _A_ref(_layernorm(x, axis=-1), A_dft_seq_re, A_dft_seq_im, A_dft_hid_re, A_dft_hid_im)
    h2 = h + _B_ref(_layernorm(h, axis=-1), B_w_r, B_w_gate, B_w_up, B_w_down)
    return h2
```

```asm
; @launch grid=(256,1,1) block=(512,1,1) lds=157952
.amdgcn_target "amdgcn-amd-amdhsa--gfx950"
.text
.globl sequential_preLN__spectral_fnet__moe_arch_mod__prompt_kernel
.p2align 8
.type sequential_preLN__spectral_fnet__moe_arch_mod__prompt_kernel,@function
sequential_preLN__spectral_fnet__moe_arch_mod__prompt_kernel:
    s_cmp_ge_u32 s2, 256
    s_cbranch_scc1 L_ka_end
    s_load_dwordx2 s[4:5], s[0:1], 0
    s_getpc_b64 s[92:93]
L_ka_pc:
    s_sub_u32 s92, s92, L_ka_pc-sequential_preLN__spectral_fnet__moe_arch_mod__prompt_kernel
    s_subb_u32 s93, s93, 0
    s_mov_b32 s94, L_code_end-sequential_preLN__spectral_fnet__moe_arch_mod__prompt_kernel
    s_mov_b32 s95, 0x20000
    s_cmp_ge_u32 s2, 16
    s_cbranch_scc1 L_ka_nocw
    v_lshlrev_b32 v4, 7, v0
    buffer_load_dword v227, v4, s[92:95], 0 offen
L_ka_nocw:
    s_load_dwordx2 s[6:7], s[0:1], 96
    s_load_dwordx8 s[44:51], s[0:1], 48
    s_load_dwordx2 s[60:61], s[0:1], 88
    v_lshrrev_b32 v1, 6, v0
    v_and_b32 v2, 15, v0
    v_readfirstlane_b32 s43, v1
    v_bfe_u32 v3, v0, 4, 2
    v_and_b32 v1, 63, v0
    s_cmp_ge_u32 s2, 224
    s_cbranch_scc1 L_ka_spare
    s_and_b32 s16, s43, 3
    s_and_b32 s20, s2, 31
    s_lshr_b32 s19, s2, 5
    s_lshr_b32 s21, s16, 1
    s_and_b32 s22, s16, 1
    s_mul_i32 s29, s16, 14336
    s_add_u32 s41, s29, 57344
    s_mov_b32 s28, 0x3f803f80
    s_cmp_lt_u32 s43, 4
    s_cbranch_scc1 L_ka_main
    s_setprio 2
    v_lshrrev_b32 v4, 3, v1
    v_and_b32 v5, 7, v1
    v_and_b32 v6, 6, v4
    v_xor_b32 v5, v5, v6
    v_lshrrev_b32 v6, 2, v4
    v_and_b32 v4, 3, v4
    v_lshl_add_u32 v6, v6, 3, v4
    v_mul_u32_u24 v6, 28672, v6
    v_lshl_add_u32 v6, v5, 4, v6
    v_add_u32 v13, 458752, v6
    s_lshl_b32 s23, s21, 10
    s_lshl_b32 s24, s22, 7
    s_add_u32 s23, s23, s24
    s_add_u32 s23, s23, s20
    s_mul_i32 s23, s23, 896
    s_lshl_b32 s31, s19, 7
    s_add_u32 s32, s23, 896
    s_add_u32 s31, s31, s23
    s_waitcnt lgkmcnt(0)
    s_mov_b32 s8, s4
    s_mov_b32 s9, s5
    s_mov_b32 s10, 0x1c0000
    s_mov_b32 s11, 0x20000
    s_add_u32 m0, s41, 0
    s_add_u32 s33, s31, 128
    buffer_load_dwordx4 v6, s[8:11], s31 offen nt lds
    s_add_u32 m0, s41, 1024
    s_cmp_eq_u32 s33, s32
    buffer_load_dwordx4 v13, s[8:11], s31 offen nt lds
    s_cselect_b32 s31, s23, s33
    s_add_u32 m0, s41, 2048
    s_add_u32 s33, s31, 128
    buffer_load_dwordx4 v6, s[8:11], s31 offen nt lds
    s_add_u32 m0, s41, 3072
    s_cmp_eq_u32 s33, s32
    buffer_load_dwordx4 v13, s[8:11], s31 offen nt lds
    s_cselect_b32 s31, s23, s33
    s_add_u32 m0, s41, 4096
    s_add_u32 s33, s31, 128
    buffer_load_dwordx4 v6, s[8:11], s31 offen nt lds
    s_add_u32 m0, s41, 5120
    s_cmp_eq_u32 s33, s32
    buffer_load_dwordx4 v13, s[8:11], s31 offen nt lds
    s_cselect_b32 s31, s23, s33
    s_add_u32 m0, s41, 6144
    s_add_u32 s33, s31, 128
    buffer_load_dwordx4 v6, s[8:11], s31 offen nt lds
    s_add_u32 m0, s41, 7168
    s_cmp_eq_u32 s33, s32
    buffer_load_dwordx4 v13, s[8:11], s31 offen nt lds
    s_cselect_b32 s31, s23, s33
    s_branch L_ka_help2
L_ka_main:
    v_lshrrev_b32 v4, 2, v2
    v_and_b32 v5, 3, v2
    s_lshl_b32 s24, s19, 6
    s_lshl_b32 s25, s21, 5
    s_add_u32 s25, s24, s25
    s_lshl_b32 s26, s22, 2
    s_add_u32 s25, s25, s26
    v_lshl_add_u32 v7, v4, 3, v5
    v_add_u32 v7, s25, v7
    v_lshrrev_b32 v8, 5, v7
    v_and_b32 v9, 15, v7
    v_lshl_add_u32 v8, v8, 4, v9
    v_cmp_eq_u32 vcc, 0, v7
    v_bfe_u32 v10, v7, 4, 1
    v_mov_b32 v9, 224
    v_cndmask_b32 v7, v8, v9, vcc
    v_mul_u32_u24 v10, 0x3e80, v10
    v_lshlrev_b32 v10, 16, v10
    v_lshl_add_u32 v8, v3, 3, s24
    v_mul_u32_u24 v8, v8, v7
    v_cvt_f32_u32 v7, v7
    v_cvt_f32_u32 v8, v8
    s_mov_b32 s24, 0x3b124925
    v_mul_f32 v9, s24, v8
    v_floor_f32 v9, v9
    v_fmamk_f32 v8, v9, 0xc3e00000, v8
    v_mul_f32 v7, s24, v7
    v_fma_f32 v8, v8, s24, v10
    v_mul_f32 v9, 0x42000000, v7
    v_cos_f32 v88, v9
    v_cos_f32 v64, v8
    v_sub_f32 v11, v8, v9
    v_add_f32 v8, v8, v7
    v_cos_f32 v72, v11
    v_cos_f32 v65, v8
    v_sub_f32 v11, v8, v9
    v_add_f32 v8, v8, v7
    v_cos_f32 v73, v11
    v_cos_f32 v66, v8
    v_sub_f32 v11, v8, v9
    v_add_f32 v8, v8, v7
    v_cos_f32 v74, v11
    v_cos_f32 v67, v8
    v_sub_f32 v11, v8, v9
    v_add_f32 v8, v8, v7
    v_cos_f32 v75, v11
    v_cos_f32 v68, v8
    v_sub_f32 v11, v8, v9
    v_add_f32 v8, v8, v7
    v_cos_f32 v76, v11
    v_cos_f32 v69, v8
    v_sub_f32 v11, v8, v9
    v_add_f32 v8, v8, v7
    v_cos_f32 v77, v11
    v_cos_f32 v70, v8
    v_sub_f32 v11, v8, v9
    v_add_f32 v8, v8, v7
    v_cos_f32 v78, v11
    v_cos_f32 v71, v8
    v_sub_f32 v11, v8, v9
    v_cos_f32 v79, v11
    v_add_f32 v88, v88, v88
    v_lshl_add_u32 v91, v1, 4, s29
    v_mov_b32 v89, v88
.p2align 3
    v_cvt_pk_bf16_f32 v80, v64, v65
    v_cvt_pk_bf16_f32 v81, v66, v67
    v_cvt_pk_bf16_f32 v82, v68, v69
    v_cvt_pk_bf16_f32 v83, v70, v71
    ds_write_b128 v91, v[80:83] offset:0
    v_pk_fma_f32 v[72:73], v[88:89], v[64:65], v[72:73] neg_lo:[0,0,1] neg_hi:[0,0,1]
    v_pk_fma_f32 v[74:75], v[88:89], v[66:67], v[74:75] neg_lo:[0,0,1] neg_hi:[0,0,1]
    v_pk_fma_f32 v[76:77], v[88:89], v[68:69], v[76:77] neg_lo:[0,0,1] neg_hi:[0,0,1]
    v_pk_fma_f32 v[78:79], v[88:89], v[70:71], v[78:79] neg_lo:[0,0,1] neg_hi:[0,0,1]
    v_cvt_pk_bf16_f32 v84, v72, v73
    v_cvt_pk_bf16_f32 v85, v74, v75
    v_cvt_pk_bf16_f32 v86, v76, v77
    v_cvt_pk_bf16_f32 v87, v78, v79
    ds_write_b128 v91, v[84:87] offset:1024
    v_pk_fma_f32 v[64:65], v[88:89], v[72:73], v[64:65] neg_lo:[0,0,1] neg_hi:[0,0,1]
    v_pk_fma_f32 v[66:67], v[88:89], v[74:75], v[66:67] neg_lo:[0,0,1] neg_hi:[0,0,1]
    v_pk_fma_f32 v[68:69], v[88:89], v[76:77], v[68:69] neg_lo:[0,0,1] neg_hi:[0,0,1]
    v_pk_fma_f32 v[70:71], v[88:89], v[78:79], v[70:71] neg_lo:[0,0,1] neg_hi:[0,0,1]
    v_cvt_pk_bf16_f32 v80, v64, v65
    v_cvt_pk_bf16_f32 v81, v66, v67
    v_cvt_pk_bf16_f32 v82, v68, v69
    v_cvt_pk_bf16_f32 v83, v70, v71
    ds_write_b128 v91, v[80:83] offset:2048
    v_pk_fma_f32 v[72:73], v[88:89], v[64:65], v[72:73] neg_lo:[0,0,1] neg_hi:[0,0,1]
    v_pk_fma_f32 v[74:75], v[88:89], v[66:67], v[74:75] neg_lo:[0,0,1] neg_hi:[0,0,1]
    v_pk_fma_f32 v[76:77], v[88:89], v[68:69], v[76:77] neg_lo:[0,0,1] neg_hi:[0,0,1]
    v_pk_fma_f32 v[78:79], v[88:89], v[70:71], v[78:79] neg_lo:[0,0,1] neg_hi:[0,0,1]
    v_cvt_pk_bf16_f32 v84, v72, v73
    v_cvt_pk_bf16_f32 v85, v74, v75
    v_cvt_pk_bf16_f32 v86, v76, v77
    v_cvt_pk_bf16_f32 v87, v78, v79
    ds_write_b128 v91, v[84:87] offset:3072
    v_pk_fma_f32 v[64:65], v[88:89], v[72:73], v[64:65] neg_lo:[0,0,1] neg_hi:[0,0,1]
    v_pk_fma_f32 v[66:67], v[88:89], v[74:75], v[66:67] neg_lo:[0,0,1] neg_hi:[0,0,1]
    v_pk_fma_f32 v[68:69], v[88:89], v[76:77], v[68:69] neg_lo:[0,0,1] neg_hi:[0,0,1]
    v_pk_fma_f32 v[70:71], v[88:89], v[78:79], v[70:71] neg_lo:[0,0,1] neg_hi:[0,0,1]
    v_cvt_pk_bf16_f32 v80, v64, v65
    v_cvt_pk_bf16_f32 v81, v66, v67
    v_cvt_pk_bf16_f32 v82, v68, v69
    v_cvt_pk_bf16_f32 v83, v70, v71
    ds_write_b128 v91, v[80:83] offset:4096
    v_pk_fma_f32 v[72:73], v[88:89], v[64:65], v[72:73] neg_lo:[0,0,1] neg_hi:[0,0,1]
    v_pk_fma_f32 v[74:75], v[88:89], v[66:67], v[74:75] neg_lo:[0,0,1] neg_hi:[0,0,1]
    v_pk_fma_f32 v[76:77], v[88:89], v[68:69], v[76:77] neg_lo:[0,0,1] neg_hi:[0,0,1]
    v_pk_fma_f32 v[78:79], v[88:89], v[70:71], v[78:79] neg_lo:[0,0,1] neg_hi:[0,0,1]
    v_cvt_pk_bf16_f32 v84, v72, v73
    v_cvt_pk_bf16_f32 v85, v74, v75
    v_cvt_pk_bf16_f32 v86, v76, v77
    v_cvt_pk_bf16_f32 v87, v78, v79
    ds_write_b128 v91, v[84:87] offset:5120
    v_pk_fma_f32 v[64:65], v[88:89], v[72:73], v[64:65] neg_lo:[0,0,1] neg_hi:[0,0,1]
    v_pk_fma_f32 v[66:67], v[88:89], v[74:75], v[66:67] neg_lo:[0,0,1] neg_hi:[0,0,1]
    v_pk_fma_f32 v[68:69], v[88:89], v[76:77], v[68:69] neg_lo:[0,0,1] neg_hi:[0,0,1]
    v_pk_fma_f32 v[70:71], v[88:89], v[78:79], v[70:71] neg_lo:[0,0,1] neg_hi:[0,0,1]
    v_cvt_pk_bf16_f32 v80, v64, v65
    v_cvt_pk_bf16_f32 v81, v66, v67
    v_cvt_pk_bf16_f32 v82, v68, v69
    v_cvt_pk_bf16_f32 v83, v70, v71
    ds_write_b128 v91, v[80:83] offset:6144
    v_pk_fma_f32 v[72:73], v[88:89], v[64:65], v[72:73] neg_lo:[0,0,1] neg_hi:[0,0,1]
    v_pk_fma_f32 v[74:75], v[88:89], v[66:67], v[74:75] neg_lo:[0,0,1] neg_hi:[0,0,1]
    v_pk_fma_f32 v[76:77], v[88:89], v[68:69], v[76:77] neg_lo:[0,0,1] neg_hi:[0,0,1]
    v_pk_fma_f32 v[78:79], v[88:89], v[70:71], v[78:79] neg_lo:[0,0,1] neg_hi:[0,0,1]
    v_cvt_pk_bf16_f32 v84, v72, v73
    v_cvt_pk_bf16_f32 v85, v74, v75
    v_cvt_pk_bf16_f32 v86, v76, v77
    v_cvt_pk_bf16_f32 v87, v78, v79
    ds_write_b128 v91, v[84:87] offset:7168
    v_pk_fma_f32 v[64:65], v[88:89], v[72:73], v[64:65] neg_lo:[0,0,1] neg_hi:[0,0,1]
    v_pk_fma_f32 v[66:67], v[88:89], v[74:75], v[66:67] neg_lo:[0,0,1] neg_hi:[0,0,1]
    v_pk_fma_f32 v[68:69], v[88:89], v[76:77], v[68:69] neg_lo:[0,0,1] neg_hi:[0,0,1]
    v_pk_fma_f32 v[70:71], v[88:89], v[78:79], v[70:71] neg_lo:[0,0,1] neg_hi:[0,0,1]
    v_cvt_pk_bf16_f32 v80, v64, v65
    v_cvt_pk_bf16_f32 v81, v66, v67
    v_cvt_pk_bf16_f32 v82, v68, v69
    v_cvt_pk_bf16_f32 v83, v70, v71
    ds_write_b128 v91, v[80:83] offset:8192
    v_pk_fma_f32 v[72:73], v[88:89], v[64:65], v[72:73] neg_lo:[0,0,1] neg_hi:[0,0,1]
    v_pk_fma_f32 v[74:75], v[88:89], v[66:67], v[74:75] neg_lo:[0,0,1] neg_hi:[0,0,1]
    v_pk_fma_f32 v[76:77], v[88:89], v[68:69], v[76:77] neg_lo:[0,0,1] neg_hi:[0,0,1]
    v_pk_fma_f32 v[78:79], v[88:89], v[70:71], v[78:79] neg_lo:[0,0,1] neg_hi:[0,0,1]
    v_cvt_pk_bf16_f32 v84, v72, v73
    v_cvt_pk_bf16_f32 v85, v74, v75
    v_cvt_pk_bf16_f32 v86, v76, v77
    v_cvt_pk_bf16_f32 v87, v78, v79
    ds_write_b128 v91, v[84:87] offset:9216
    v_pk_fma_f32 v[64:65], v[88:89], v[72:73], v[64:65] neg_lo:[0,0,1] neg_hi:[0,0,1]
    v_pk_fma_f32 v[66:67], v[88:89], v[74:75], v[66:67] neg_lo:[0,0,1] neg_hi:[0,0,1]
    v_pk_fma_f32 v[68:69], v[88:89], v[76:77], v[68:69] neg_lo:[0,0,1] neg_hi:[0,0,1]
    v_pk_fma_f32 v[70:71], v[88:89], v[78:79], v[70:71] neg_lo:[0,0,1] neg_hi:[0,0,1]
    v_cvt_pk_bf16_f32 v80, v64, v65
    v_cvt_pk_bf16_f32 v81, v66, v67
    v_cvt_pk_bf16_f32 v82, v68, v69
    v_cvt_pk_bf16_f32 v83, v70, v71
    ds_write_b128 v91, v[80:83] offset:10240
    v_pk_fma_f32 v[72:73], v[88:89], v[64:65], v[72:73] neg_lo:[0,0,1] neg_hi:[0,0,1]
    v_pk_fma_f32 v[74:75], v[88:89], v[66:67], v[74:75] neg_lo:[0,0,1] neg_hi:[0,0,1]
    v_pk_fma_f32 v[76:77], v[88:89], v[68:69], v[76:77] neg_lo:[0,0,1] neg_hi:[0,0,1]
    v_pk_fma_f32 v[78:79], v[88:89], v[70:71], v[78:79] neg_lo:[0,0,1] neg_hi:[0,0,1]
    v_cvt_pk_bf16_f32 v84, v72, v73
    v_cvt_pk_bf16_f32 v85, v74, v75
    v_cvt_pk_bf16_f32 v86, v76, v77
    v_cvt_pk_bf16_f32 v87, v78, v79
    ds_write_b128 v91, v[84:87] offset:11264
    v_pk_fma_f32 v[64:65], v[88:89], v[72:73], v[64:65] neg_lo:[0,0,1] neg_hi:[0,0,1]
    v_pk_fma_f32 v[66:67], v[88:89], v[74:75], v[66:67] neg_lo:[0,0,1] neg_hi:[0,0,1]
    v_pk_fma_f32 v[68:69], v[88:89], v[76:77], v[68:69] neg_lo:[0,0,1] neg_hi:[0,0,1]
    v_pk_fma_f32 v[70:71], v[88:89], v[78:79], v[70:71] neg_lo:[0,0,1] neg_hi:[0,0,1]
    v_cvt_pk_bf16_f32 v80, v64, v65
    v_cvt_pk_bf16_f32 v81, v66, v67
    v_cvt_pk_bf16_f32 v82, v68, v69
    v_cvt_pk_bf16_f32 v83, v70, v71
    ds_write_b128 v91, v[80:83] offset:12288
    v_pk_fma_f32 v[72:73], v[88:89], v[64:65], v[72:73] neg_lo:[0,0,1] neg_hi:[0,0,1]
    v_pk_fma_f32 v[74:75], v[88:89], v[66:67], v[74:75] neg_lo:[0,0,1] neg_hi:[0,0,1]
    v_pk_fma_f32 v[76:77], v[88:89], v[68:69], v[76:77] neg_lo:[0,0,1] neg_hi:[0,0,1]
    v_pk_fma_f32 v[78:79], v[88:89], v[70:71], v[78:79] neg_lo:[0,0,1] neg_hi:[0,0,1]
    v_cvt_pk_bf16_f32 v84, v72, v73
    v_cvt_pk_bf16_f32 v85, v74, v75
    v_cvt_pk_bf16_f32 v86, v76, v77
    v_cvt_pk_bf16_f32 v87, v78, v79
    ds_write_b128 v91, v[84:87] offset:13312
    v_lshlrev_b32 v11, 4, v1
    s_waitcnt lgkmcnt(0)
    s_barrier
    ds_read_b128 v[192:195], v11 offset:0
    ds_read_b128 v[196:199], v11 offset:14336
    ds_read_b128 v[200:203], v11 offset:28672
    ds_read_b128 v[204:207], v11 offset:43008
    ds_read_b128 v[208:211], v11 offset:1024
    ds_read_b128 v[212:215], v11 offset:15360
    ds_read_b128 v[216:219], v11 offset:29696
    ds_read_b128 v[220:223], v11 offset:44032
    v_lshlrev_b32 v11, 4, v1
    v_and_b32 v12, 6, v2
    v_xor_b32 v12, v12, v3
    v_and_b32 v14, 7, v2
    v_lshlrev_b32 v14, 7, v14
    v_lshl_add_u32 v14, v12, 4, v14
    v_lshrrev_b32 v12, 3, v2
    v_lshl_add_u32 v14, v12, 10, v14
    v_add_u32 v14, s41, v14
    v_xor_b32 v15, 64, v14
    v_lshrrev_b32 v12, 2, v1
    v_and_b32 v8, 3, v1
    v_bfe_u32 v10, v1, 3, 2
    v_xor_b32 v10, v10, v8
    v_lshlrev_b32 v10, 4, v10
    v_lshl_add_u32 v10, v12, 6, v10
    s_lshl_b32 s24, s43, 10
    s_add_u32 s24, s24, 132096
    v_add_u32 v10, s24, v10
    v_bfe_u32 v12, v2, 1, 2
    v_xor_b32 v12, v12, v3
    v_lshlrev_b32 v12, 4, v12
    v_lshl_add_u32 v12, v2, 6, v12
    v_add_u32 v8, s24, v12
    s_lshl_b32 s24, s16, 11
    s_add_u32 s24, s24, 122880
    v_add_u32 v52, s24, v11
    s_lshl_b32 s24, s21, 10
    s_lshl_b32 s25, s22, 3
    s_add_u32 s24, s24, s25
    s_add_u32 s24, s24, 114688
    v_add_u32 v55, s24, v11
    v_lshlrev_b32 v12, 4, v2
    s_lshl_b32 s26, s19, 8
    s_add_u32 s26, s26, fnet_tables-sequential_preLN__spectral_fnet__moe_arch_mod__prompt_kernel+8192
    s_lshl_b32 s25, s16, 7
    s_add_u32 s25, s25, 131072
    v_lshl_add_u32 v13, v3, 4, s25
    buffer_load_dwordx4 v[44:47], v12, s[92:95], s26 offen
    s_mov_b32 s12, s6
    s_mov_b32 s13, s7
    s_mov_b32 s14, 0x10000000
    s_mov_b32 s15, 0x20000
    s_mov_b32 s56, s60
    s_mov_b32 s57, s61
    s_mov_b32 s58, 0x100
    s_mov_b32 s59, 0x20000
    ds_read_b128 v[96:99], v11 offset:2048
    ds_read_b128 v[100:103], v11 offset:16384
    ds_read_b128 v[104:107], v11 offset:30720
    ds_read_b128 v[108:111], v11 offset:45056
    ds_read_b128 v[112:115], v11 offset:3072
    ds_read_b128 v[116:119], v11 offset:17408
    ds_read_b128 v[120:123], v11 offset:31744
    ds_read_b128 v[124:127], v11 offset:46080
    v_lshrrev_b32 v53, 2, v1
    v_mul_u32_u24 v53, 57856, v53
    v_and_b32 v54, 3, v1
    v_lshl_add_u32 v53, v54, 4, v53
    s_mul_i32 s24, s22, 925696
    s_mul_i32 s25, s21, 28928
    s_add_u32 s24, s24, s25
    s_lshl_b32 s25, s19, 7
    s_add_u32 s24, s24, s25
    s_mul_i32 s25, s20, 896
    s_add_u32 s30, s24, s25
    s_cmp_ge_u32 s2, 8
    s_cselect_b32 s34, -1, 0
    s_lshl_b32 s35, s2, 12
    s_add_u32 s35, s35, 3145728
    s_cmp_ge_u32 s2, 204
    s_cselect_b32 s36, 0x7ff00000, 0
    v_lshl_add_u32 v54, v0, 4, s36
    v_mov_b32 v56, -1
    v_mov_b32 v60, s34
    v_mov_b32 v57, -1
    v_mov_b32 v61, s34
    v_mov_b32 v58, -1
    v_mov_b32 v62, s34
    v_mov_b32 v59, -1
    v_mov_b32 v63, s34
    s_barrier
    ds_read_b128 v[32:35], v14 offset:0
    ds_read_b128 v[36:39], v15 offset:0
    s_waitcnt lgkmcnt(1)
    v_mfma_f32_16x16x32_bf16 v[16:19], v[32:35], v[192:195], 0
    ds_read_b128 v[40:43], v14 offset:2048
    ds_read_b128 v[128:131], v11 offset:4096
    v_mfma_f32_16x16x32_bf16 v[20:23], v[32:35], v[196:199], 0
    ds_read_b128 v[132:135], v11 offset:18432
    v_mfma_f32_16x16x32_bf16 v[24:27], v[32:35], v[200:203], 0
    ds_read_b128 v[136:139], v11 offset:32768
    v_mfma_f32_16x16x32_bf16 v[28:31], v[32:35], v[204:207], 0
    ds_read_b128 v[140:143], v11 offset:47104
    s_waitcnt lgkmcnt(5)
    v_mfma_f32_16x16x32_bf16 v[16:19], v[36:39], v[208:211], v[16:19]
    ds_read_b128 v[32:35], v15 offset:2048
    ds_read_b128 v[144:147], v11 offset:5120
    v_mfma_f32_16x16x32_bf16 v[20:23], v[36:39], v[212:215], v[20:23]
    ds_read_b128 v[148:151], v11 offset:19456
    v_mfma_f32_16x16x32_bf16 v[24:27], v[36:39], v[216:219], v[24:27]
    ds_read_b128 v[152:155], v11 offset:33792
    v_mfma_f32_16x16x32_bf16 v[28:31], v[36:39], v[220:223], v[28:31]
    ds_read_b128 v[156:159], v11 offset:48128
    s_barrier
    s_waitcnt lgkmcnt(9)
    v_mfma_f32_16x16x32_bf16 v[16:19], v[40:43], v[96:99], v[16:19]
    ds_read_b128 v[36:39], v14 offset:4096
    ds_read_b128 v[160:163], v11 offset:6144
    v_mfma_f32_16x16x32_bf16 v[20:23], v[40:43], v[100:103], v[20:23]
    ds_read_b128 v[164:167], v11 offset:20480
    v_mfma_f32_16x16x32_bf16 v[24:27], v[40:43], v[104:107], v[24:27]
    ds_read_b128 v[168:171], v11 offset:34816
    v_mfma_f32_16x16x32_bf16 v[28:31], v[40:43], v[108:111], v[28:31]
    ds_read_b128 v[172:175], v11 offset:49152
    s_waitcnt lgkmcnt(9)
    v_mfma_f32_16x16x32_bf16 v[16:19], v[32:35], v[112:115], v[16:19]
    ds_read_b128 v[40:43], v15 offset:4096
    ds_read_b128 v[176:179], v11 offset:7168
    v_mfma_f32_16x16x32_bf16 v[20:23], v[32:35], v[116:119], v[20:23]
    ds_read_b128 v[180:183], v11 offset:21504
    v_mfma_f32_16x16x32_bf16 v[24:27], v[32:35], v[120:123], v[24:27]
    ds_read_b128 v[184:187], v11 offset:35840
    v_mfma_f32_16x16x32_bf16 v[28:31], v[32:35], v[124:127], v[28:31]
    ds_read_b128 v[188:191], v11 offset:50176
    s_waitcnt lgkmcnt(9)
    v_mfma_f32_16x16x32_bf16 v[16:19], v[36:39], v[128:131], v[16:19]
    ds_read_b128 v[32:35], v14 offset:6144
    ds_read_b128 v[192:195], v11 offset:8192
    v_mfma_f32_16x16x32_bf16 v[20:23], v[36:39], v[132:135], v[20:23]
    ds_read_b128 v[196:199], v11 offset:22528
    v_mfma_f32_16x16x32_bf16 v[24:27], v[36:39], v[136:139], v[24:27]
    ds_read_b128 v[200:203], v11 offset:36864
    v_mfma_f32_16x16x32_bf16 v[28:31], v[36:39], v[140:143], v[28:31]
    ds_read_b128 v[204:207], v11 offset:51200
    s_waitcnt lgkmcnt(9)
    v_mfma_f32_16x16x32_bf16 v[16:19], v[40:43], v[144:147], v[16:19]
    ds_read_b128 v[36:39], v15 offset:6144
    ds_read_b128 v[208:211], v11 offset:9216
    v_mfma_f32_16x16x32_bf16 v[20:23], v[40:43], v[148:151], v[20:23]
    ds_read_b128 v[212:215], v11 offset:23552
    v_mfma_f32_16x16x32_bf16 v[24:27], v[40:43], v[152:155], v[24:27]
    ds_read_b128 v[216:219], v11 offset:37888
    v_mfma_f32_16x16x32_bf16 v[28:31], v[40:43], v[156:159], v[28:31]
    ds_read_b128 v[220:223], v11 offset:52224
    s_waitcnt vmcnt(0)
    buffer_store_dwordx4 v[56:59], v53, s[12:15], s30 offen sc1
    buffer_store_dwordx4 v[56:59], v53, s[12:15], s30 offen offset:64 sc1
    buffer_store_dwordx4 v[60:63], v54, s[12:15], s35 offen sc1
    s_barrier
    buffer_load_dwordx2 v[224:225], off, s[56:59], 0 sc1
    s_waitcnt lgkmcnt(9)
    v_mfma_f32_16x16x32_bf16 v[16:19], v[32:35], v[160:163], v[16:19]
    ds_read_b128 v[40:43], v14 offset:8192
    ds_read_b128 v[96:99], v11 offset:10240
    v_mfma_f32_16x16x32_bf16 v[20:23], v[32:35], v[164:167], v[20:23]
    ds_read_b128 v[100:103], v11 offset:24576
    v_mfma_f32_16x16x32_bf16 v[24:27], v[32:35], v[168:171], v[24:27]
    ds_read_b128 v[104:107], v11 offset:38912
    v_mfma_f32_16x16x32_bf16 v[28:31], v[32:35], v[172:175], v[28:31]
    ds_read_b128 v[108:111], v11 offset:53248
    s_waitcnt lgkmcnt(9)
    v_mfma_f32_16x16x32_bf16 v[16:19], v[36:39], v[176:179], v[16:19]
    ds_read_b128 v[32:35], v15 offset:8192
    ds_read_b128 v[112:115], v11 offset:11264
    v_mfma_f32_16x16x32_bf16 v[20:23], v[36:39], v[180:183], v[20:23]
    ds_read_b128 v[116:119], v11 offset:25600
    v_mfma_f32_16x16x32_bf16 v[24:27], v[36:39], v[184:187], v[24:27]
    ds_read_b128 v[120:123], v11 offset:39936
    v_mfma_f32_16x16x32_bf16 v[28:31], v[36:39], v[188:191], v[28:31]
    ds_read_b128 v[124:127], v11 offset:54272
    s_waitcnt lgkmcnt(9)
    v_mfma_f32_16x16x32_bf16 v[16:19], v[40:43], v[192:195], v[16:19]
    ds_read_b128 v[36:39], v14 offset:10240
    ds_read_b128 v[128:131], v11 offset:12288
    v_mfma_f32_16x16x32_bf16 v[20:23], v[40:43], v[196:199], v[20:23]
    ds_read_b128 v[132:135], v11 offset:26624
    v_mfma_f32_16x16x32_bf16 v[24:27], v[40:43], v[200:203], v[24:27]
    ds_read_b128 v[136:139], v11 offset:40960
    v_mfma_f32_16x16x32_bf16 v[28:31], v[40:43], v[204:207], v[28:31]
    ds_read_b128 v[140:143], v11 offset:55296
    s_waitcnt lgkmcnt(9)
    v_mfma_f32_16x16x32_bf16 v[16:19], v[32:35], v[208:211], v[16:19]
    ds_read_b128 v[40:43], v15 offset:10240
    ds_read_b128 v[144:147], v11 offset:13312
    v_mfma_f32_16x16x32_bf16 v[20:23], v[32:35], v[212:215], v[20:23]
    ds_read_b128 v[148:151], v11 offset:27648
    v_mfma_f32_16x16x32_bf16 v[24:27], v[32:35], v[216:219], v[24:27]
    ds_read_b128 v[152:155], v11 offset:41984
    v_mfma_f32_16x16x32_bf16 v[28:31], v[32:35], v[220:223], v[28:31]
    ds_read_b128 v[156:159], v11 offset:56320
    s_waitcnt lgkmcnt(9)
    v_mfma_f32_16x16x32_bf16 v[16:19], v[36:39], v[96:99], v[16:19]
    ds_read_b128 v[32:35], v14 offset:12288
    v_mfma_f32_16x16x32_bf16 v[20:23], v[36:39], v[100:103], v[20:23]
    v_mfma_f32_16x16x32_bf16 v[24:27], v[36:39], v[104:107], v[24:27]
    v_mfma_f32_16x16x32_bf16 v[28:31], v[36:39], v[108:111], v[28:31]
    s_barrier
    ds_read_b128 v[64:67], v13
    ds_read_b128 v[68:71], v13 offset:64
    s_waitcnt lgkmcnt(7)
    v_mfma_f32_16x16x32_bf16 v[16:19], v[40:43], v[112:115], v[16:19]
    ds_read_b128 v[36:39], v15 offset:12288
    v_mfma_f32_16x16x32_bf16 v[20:23], v[40:43], v[116:119], v[20:23]
    v_mfma_f32_16x16x32_bf16 v[24:27], v[40:43], v[120:123], v[24:27]
    v_mfma_f32_16x16x32_bf16 v[28:31], v[40:43], v[124:127], v[28:31]
    s_waitcnt lgkmcnt(1)
    v_mfma_f32_16x16x32_bf16 v[16:19], v[32:35], v[128:131], v[16:19]
    ds_read_b128 v[56:59], v52 offset:0
    v_mul_f32 v72, v64, v44
    v_mul_f32 v73, v65, v44
    v_mul_f32 v74, v66, v44
    v_mfma_f32_16x16x32_bf16 v[20:23], v[32:35], v[132:135], v[20:23]
    ds_read_b128 v[60:63], v52 offset:1024
    v_mul_f32 v75, v67, v44
    v_mul_f32 v76, v64, v45
    v_mul_f32 v77, v65, v45
    v_mfma_f32_16x16x32_bf16 v[24:27], v[32:35], v[136:139], v[24:27]
    v_mul_f32 v78, v66, v45
    v_mul_f32 v79, v67, v45
    v_mul_f32 v80, v64, v46
    v_mfma_f32_16x16x32_bf16 v[28:31], v[32:35], v[140:143], v[28:31]
    v_mul_f32 v81, v65, v46
    v_mul_f32 v82, v66, v46
    v_mul_f32 v83, v67, v46
    s_waitcnt lgkmcnt(2)
    v_mfma_f32_16x16x32_bf16 v[16:19], v[36:39], v[144:147], v[16:19]
    v_mul_f32 v84, v64, v47
    v_mul_f32 v85, v65, v47
    v_mul_f32 v86, v66, v47
    v_mfma_f32_16x16x32_bf16 v[20:23], v[36:39], v[148:151], v[20:23]
    v_mul_f32 v87, v67, v47
    v_mfma_f32_16x16x32_bf16 v[24:27], v[36:39], v[152:155], v[24:27]
    v_mfma_f32_16x16x32_bf16 v[28:31], v[36:39], v[156:159], v[28:31]
    s_nop 4
    v_pk_fma_f32 v[16:17], v[16:17], v[68:69], v[72:73]
    v_pk_fma_f32 v[18:19], v[18:19], v[70:71], v[74:75]
    v_cvt_pk_bf16_f32 v32, v16, v17
    v_cvt_pk_bf16_f32 v33, v18, v19
    ds_write_b64 v55, v[32:33] offset:0
    v_pk_fma_f32 v[20:21], v[20:21], v[68:69], v[76:77]
    v_pk_fma_f32 v[22:23], v[22:23], v[70:71], v[78:79]
    v_cvt_pk_bf16_f32 v34, v20, v21
    v_cvt_pk_bf16_f32 v35, v22, v23
    ds_write_b64 v55, v[34:35] offset:2048
    v_pk_fma_f32 v[24:25], v[24:25], v[68:69], v[80:81]
    v_pk_fma_f32 v[26:27], v[26:27], v[70:71], v[82:83]
    v_cvt_pk_bf16_f32 v36, v24, v25
    v_cvt_pk_bf16_f32 v37, v26, v27
    ds_write_b64 v55, v[36:37] offset:4096
    v_pk_fma_f32 v[28:29], v[28:29], v[68:69], v[84:85]
    v_pk_fma_f32 v[30:31], v[30:31], v[70:71], v[86:87]
    v_cvt_pk_bf16_f32 v38, v28, v29
    v_cvt_pk_bf16_f32 v39, v30, v31
    ds_write_b64 v55, v[38:39] offset:6144
    s_waitcnt lgkmcnt(0)
    v_add_u32 v54, 114688, v11
    s_waitcnt vmcnt(0)
    s_barrier
    ds_read_b128 v[64:67], v54 offset:0
    ds_read_b128 v[68:71], v54 offset:1024
    ds_read_b128 v[72:75], v54 offset:2048
    ds_read_b128 v[76:79], v54 offset:3072
    s_waitcnt lgkmcnt(2)
    v_mfma_f32_16x16x32_bf16 v[40:43], v[64:67], v[56:59], 0
    v_mfma_f32_16x16x32_bf16 v[40:43], v[68:71], v[60:63], v[40:43]
    s_waitcnt lgkmcnt(0)
    v_mfma_f32_16x16x32_bf16 v[44:47], v[72:75], v[56:59], 0
    v_mfma_f32_16x16x32_bf16 v[44:47], v[76:79], v[60:63], v[44:47]
    s_nop 4
    v_cvt_pk_bf16_f32 v16, v40, v41
    v_cvt_pk_bf16_f32 v17, v42, v43
    s_nop 0
    v_cvt_pk_bf16_f32 v18, v44, v45
    v_cvt_pk_bf16_f32 v19, v46, v47
    ds_write_b128 v8, v[16:19]
    s_waitcnt lgkmcnt(0)
    ds_read_b128 v[20:23], v10
    s_waitcnt lgkmcnt(0)
    buffer_store_dwordx4 v[20:23], v53, s[12:15], s30 offen offset:0 sc1
    v_lshlrev_b32 v226, 6, v1
    s_barrier
    s_branch L_kb_entry
L_ka_help2:
    s_setprio 0
    s_mov_b32 s12, s6
    s_mov_b32 s13, s7
    s_mov_b32 s14, 0x10000000
    s_mov_b32 s15, 0x20000
    s_mov_b32 s56, s60
    s_mov_b32 s57, s61
    s_movk_i32 s58, 256
    s_mov_b32 s59, 0x20000
    s_or_b32 s24, s2, s16
    s_cmp_lg_u32 s24, 0
    s_cbranch_scc1 L_ka_notag
    s_memrealtime s[24:25]
    s_waitcnt lgkmcnt(0)
    s_or_b32 s24, s24, 1
    v_mov_b32 v44, s24
    v_mov_b32 v45, s25
    s_mov_b64 exec, 1
    buffer_store_dwordx2 v[44:45], off, s[56:59], 0 sc1
    s_mov_b64 exec, -1
L_ka_notag:
    v_lshlrev_b32 v11, 4, v1
    v_and_b32 v12, 6, v2
    v_xor_b32 v12, v12, v3
    v_and_b32 v14, 7, v2
    v_lshlrev_b32 v14, 7, v14
    v_lshl_add_u32 v14, v12, 4, v14
    v_lshrrev_b32 v12, 3, v2
    v_lshl_add_u32 v14, v12, 10, v14
    v_add_u32 v14, s41, v14
    v_xor_b32 v15, 64, v14
    v_lshrrev_b32 v12, 2, v1
    v_and_b32 v8, 3, v1
    v_bfe_u32 v10, v1, 3, 2
    v_xor_b32 v10, v10, v8
    v_lshlrev_b32 v10, 4, v10
    v_lshl_add_u32 v10, v12, 6, v10
    s_lshl_b32 s24, s43, 10
    s_add_u32 s24, s24, 132096
    v_add_u32 v10, s24, v10
    v_bfe_u32 v12, v2, 1, 2
    v_xor_b32 v12, v12, v3
    v_lshlrev_b32 v12, 4, v12
    v_lshl_add_u32 v12, v2, 6, v12
    v_add_u32 v8, s24, v12
    s_lshl_b32 s24, s16, 11
    s_add_u32 s24, s24, 122880
    v_add_u32 v52, s24, v11
    v_lshrrev_b32 v53, 2, v1
    v_mul_u32_u24 v53, 57856, v53
    v_and_b32 v54, 3, v1
    v_lshl_add_u32 v53, v54, 4, v53
    s_mul_i32 s24, s22, 925696
    s_mul_i32 s25, s21, 28928
    s_add_u32 s24, s24, s25
    s_lshl_b32 s25, s19, 7
    s_add_u32 s24, s24, s25
    s_mul_i32 s25, s20, 896
    s_add_u32 s30, s24, s25
    v_mov_b32 v48, s28
    v_mov_b32 v49, s28
    v_mov_b32 v50, s28
    v_mov_b32 v51, s28
    s_mov_b32 s24, 0x3b124925
    s_mov_b32 s26, 0x3727c5ac
    s_mov_b32 s27, 0xffff0000
    s_bfe_u32 s17, s2, 0x10006
    s_lshl_b32 s17, s17, 5
    s_add_u32 s17, s17, s20
    s_bfe_u32 s18, s2, 0x10005
    s_lshl_b32 s18, s18, 10
    s_add_u32 s18, s18, s17
    s_lshl_b32 s17, s16, 8
    s_add_u32 s18, s18, s17
    s_mul_i32 s18, s18, 896
    s_mul_i32 s17, s16, 4160
    s_add_u32 s17, s17, 140288
    v_cmp_gt_u32 vcc, 56, v1
    v_mov_b32 v218, 0x7ff00000
    s_nop 0
    v_cndmask_b32 v218, v218, v11, vcc
    v_and_b32 v4, 3, v2
    v_lshrrev_b32 v5, 2, v2
    v_cmp_eq_u32 s[52:53], 1, v4
    v_cmp_eq_u32 s[54:55], 2, v4
    v_cmp_eq_u32 s[62:63], 3, v4
    v_cmp_eq_u32 s[60:61], v5, v3
    s_lshl_b32 s25, s16, 7
    s_add_u32 s25, s25, 131072
    v_lshl_add_u32 v4, v2, 2, s25
    s_lshl_b32 s40, s16, 11
    s_setprio 2
    s_barrier
    s_setprio 2
    s_waitcnt vmcnt(6)
    s_add_u32 m0, s41, 8192
    s_add_u32 s33, s31, 128
    buffer_load_dwordx4 v6, s[8:11], s31 offen nt lds
    s_add_u32 m0, s41, 9216
    s_cmp_eq_u32 s33, s32
    buffer_load_dwordx4 v13, s[8:11], s31 offen nt lds
    s_cselect_b32 s31, s23, s33
    s_waitcnt vmcnt(6)
    s_add_u32 m0, s41, 10240
    s_add_u32 s33, s31, 128
    buffer_load_dwordx4 v6, s[8:11], s31 offen nt lds
    s_add_u32 m0, s41, 11264
    s_cmp_eq_u32 s33, s32
    buffer_load_dwordx4 v13, s[8:11], s31 offen nt lds
    s_cselect_b32 s31, s23, s33
    ds_read_b128 v[64:67], v14 offset:0
    ds_read_b128 v[68:71], v15 offset:0
    ds_read_b128 v[72:75], v14 offset:2048
    ds_read_b128 v[76:79], v15 offset:2048
    s_barrier
    s_waitcnt lgkmcnt(3)
    v_mfma_f32_16x16x32_bf16 v[36:39], v[64:67], v[64:67], 0
    v_mfma_f32_16x16x32_bf16 v[32:35], v[64:67], v[48:51], 0
    s_waitcnt lgkmcnt(2)
    v_mfma_f32_16x16x32_bf16 v[36:39], v[68:71], v[68:71], v[36:39]
    v_mfma_f32_16x16x32_bf16 v[32:35], v[68:71], v[48:51], v[32:35]
    s_waitcnt vmcnt(6)
    s_add_u32 m0, s41, 12288
    s_add_u32 s33, s31, 128
    buffer_load_dwordx4 v6, s[8:11], s31 offen nt lds
    s_add_u32 m0, s41, 13312
    s_cmp_eq_u32 s33, s32
    buffer_load_dwordx4 v13, s[8:11], s31 offen nt lds
    s_cselect_b32 s31, s23, s33
    s_waitcnt lgkmcnt(1)
    v_mfma_f32_16x16x32_bf16 v[36:39], v[72:75], v[72:75], v[36:39]
    v_mfma_f32_16x16x32_bf16 v[32:35], v[72:75], v[48:51], v[32:35]
    s_waitcnt lgkmcnt(0)
    v_mfma_f32_16x16x32_bf16 v[36:39], v[76:79], v[76:79], v[36:39]
    v_mfma_f32_16x16x32_bf16 v[32:35], v[76:79], v[48:51], v[32:35]
    s_waitcnt vmcnt(6)
    ds_read_b128 v[80:83], v14 offset:4096
    ds_read_b128 v[84:87], v15 offset:4096
    ds_read_b128 v[88:91], v14 offset:6144
    ds_read_b128 v[92:95], v15 offset:6144
    s_barrier
    s_add_u32 m0, s40, 122880
    s_add_u32 s33, s40, fnet_tables-sequential_preLN__spectral_fnet__moe_arch_mod__prompt_kernel
    buffer_load_dwordx4 v11, s[92:95], s33 offen lds
    buffer_load_dwordx4 v11, s[92:95], s33 offen offset:1024 lds
    buffer_load_dwordx2 v[224:225], off, s[56:59], 0 sc1
    s_cmp_ge_u32 s2, 128
    s_cbranch_scc1 L_ka_nostage
    s_add_u32 m0, s17, 0
    s_add_u32 s33, s18, 0
    buffer_load_dwordx4 v218, s[8:11], s33 offen lds
    s_add_u32 m0, s17, 1040
    s_add_u32 s33, s18, 57344
    buffer_load_dwordx4 v218, s[8:11], s33 offen lds
    s_add_u32 m0, s17, 2080
    s_add_u32 s33, s18, 114688
    buffer_load_dwordx4 v218, s[8:11], s33 offen lds
    s_add_u32 m0, s17, 3120
    s_add_u32 s33, s18, 172032
    buffer_load_dwordx4 v218, s[8:11], s33 offen lds
    s_mov_b32 m0, 156928
    s_mov_b32 s8, s44
    s_mov_b32 s9, s45
    s_mov_b32 s10, 0x380
    s_mov_b32 s11, 0x20000
    buffer_load_dwordx4 v11, s[8:11], 0 offen lds
L_ka_nostage:
    s_waitcnt lgkmcnt(3)
    v_mfma_f32_16x16x32_bf16 v[36:39], v[80:83], v[80:83], v[36:39]
    v_mfma_f32_16x16x32_bf16 v[32:35], v[80:83], v[48:51], v[32:35]
    s_waitcnt lgkmcnt(2)
    v_mfma_f32_16x16x32_bf16 v[36:39], v[84:87], v[84:87], v[36:39]
    v_mfma_f32_16x16x32_bf16 v[32:35], v[84:87], v[48:51], v[32:35]
    s_waitcnt lgkmcnt(1)
    v_mfma_f32_16x16x32_bf16 v[36:39], v[88:91], v[88:91], v[36:39]
    v_mfma_f32_16x16x32_bf16 v[32:35], v[88:91], v[48:51], v[32:35]
    s_waitcnt lgkmcnt(0)
    v_mfma_f32_16x16x32_bf16 v[36:39], v[92:95], v[92:95], v[36:39]
    v_mfma_f32_16x16x32_bf16 v[32:35], v[92:95], v[48:51], v[32:35]
    s_cmp_ge_u32 s2, 128
    s_cbranch_scc1 L_ka_w1
    s_waitcnt vmcnt(6)
    s_branch L_ka_w2
L_ka_w1:
    s_waitcnt vmcnt(1)
L_ka_w2:
    ds_read_b128 v[96:99], v14 offset:8192
    ds_read_b128 v[100:103], v15 offset:8192
    ds_read_b128 v[104:107], v14 offset:10240
    ds_read_b128 v[108:111], v15 offset:10240
    ds_read_b128 v[112:115], v14 offset:12288
    ds_read_b128 v[116:119], v15 offset:12288
    s_waitcnt lgkmcnt(5)
    v_mfma_f32_16x16x32_bf16 v[36:39], v[96:99], v[96:99], v[36:39]
    v_mfma_f32_16x16x32_bf16 v[32:35], v[96:99], v[48:51], v[32:35]
    s_waitcnt lgkmcnt(4)
    v_mfma_f32_16x16x32_bf16 v[36:39], v[100:103], v[100:103], v[36:39]
    v_mfma_f32_16x16x32_bf16 v[32:35], v[100:103], v[48:51], v[32:35]
    s_waitcnt lgkmcnt(3)
    v_mfma_f32_16x16x32_bf16 v[36:39], v[104:107], v[104:107], v[36:39]
    v_mfma_f32_16x16x32_bf16 v[32:35], v[104:107], v[48:51], v[32:35]
    s_waitcnt lgkmcnt(2)
    v_mfma_f32_16x16x32_bf16 v[36:39], v[108:111], v[108:111], v[36:39]
    v_mfma_f32_16x16x32_bf16 v[32:35], v[108:111], v[48:51], v[32:35]
    s_waitcnt lgkmcnt(1)
    v_mfma_f32_16x16x32_bf16 v[36:39], v[112:115], v[112:115], v[36:39]
    v_mfma_f32_16x16x32_bf16 v[32:35], v[112:115], v[48:51], v[32:35]
    s_waitcnt lgkmcnt(0)
    v_mfma_f32_16x16x32_bf16 v[36:39], v[116:119], v[116:119], v[36:39]
    v_mfma_f32_16x16x32_bf16 v[32:35], v[116:119], v[48:51], v[32:35]
    s_barrier
    s_nop 6
    v_cndmask_b32 v20, v36, v37, s[52:53]
    v_cndmask_b32 v16, v32, v33, s[52:53]
    v_cndmask_b32 v20, v20, v38, s[54:55]
    v_cndmask_b32 v16, v16, v34, s[54:55]
    v_cndmask_b32 v20, v20, v39, s[62:63]
    v_cndmask_b32 v16, v16, v35, s[62:63]
    v_mul_f32 v20, s24, v20
    v_mul_f32 v16, s24, v16
    v_fma_f32 v20, -v16, v16, v20
    v_max_f32 v20, 0, v20
    v_cvt_pk_bf16_f32 v20, v20, v20
    v_and_b32 v20, s27, v20
    v_add_f32 v20, s26, v20
    v_cvt_pk_bf16_f32 v20, v20, v20
    v_and_b32 v20, s27, v20
    v_sqrt_f32 v20, v20
    s_mov_b64 exec, s[60:61]
    v_cvt_pk_bf16_f32 v20, v20, v20
    v_and_b32 v20, s27, v20
    v_rcp_f32 v20, v20
    s_nop 0
    v_mul_f32 v16, -v16, v20
    ds_write2_b32 v4, v16, v20 offset0:0 offset1:16
    s_mov_b64 exec, -1
    s_waitcnt lgkmcnt(0)
    s_barrier
    ds_read_b128 v[56:59], v52
    ds_read_b128 v[60:63], v52 offset:1024
    v_add_u32 v54, 118784, v11
    s_waitcnt vmcnt(0)
    s_barrier
    ds_read_b128 v[64:67], v54 offset:0
    ds_read_b128 v[68:71], v54 offset:1024
    ds_read_b128 v[72:75], v54 offset:2048
    ds_read_b128 v[76:79], v54 offset:3072
    s_cmp_lg_u32 s43, 4
    s_cbranch_scc1 L_ka_noflag
    s_mov_b32 s63, 0
L_taga:
    v_cmp_ne_u32 vcc, 0, v224
    s_cbranch_vccnz L_tagoka
    buffer_load_dwordx2 v[224:225], off, s[56:59], 0 sc1
    s_add_u32 s63, s63, 1
    s_waitcnt vmcnt(0)
    s_cmp_lt_u32 s63, 0x40000
    s_cbranch_scc1 L_taga
L_tagoka:
    s_lshl_b32 s24, s2, 6
    s_add_u32 s24, s24, 4063232
    s_mov_b64 exec, 1
    buffer_store_dwordx2 v[224:225], off, s[12:15], s24 sc1
    s_mov_b64 exec, -1
L_ka_noflag:
    s_waitcnt lgkmcnt(2)
    v_mfma_f32_16x16x32_bf16 v[40:43], v[64:67], v[56:59], 0
    v_mfma_f32_16x16x32_bf16 v[40:43], v[68:71], v[60:63], v[40:43]
    s_waitcnt lgkmcnt(0)
    v_mfma_f32_16x16x32_bf16 v[44:47], v[72:75], v[56:59], 0
    v_mfma_f32_16x16x32_bf16 v[44:47], v[76:79], v[60:63], v[44:47]
    s_nop 4
    v_cvt_pk_bf16_f32 v16, v40, v41
    v_cvt_pk_bf16_f32 v17, v42, v43
    s_nop 0
    v_cvt_pk_bf16_f32 v18, v44, v45
    v_cvt_pk_bf16_f32 v19, v46, v47
    ds_write_b128 v8, v[16:19]
    s_waitcnt lgkmcnt(0)
    ds_read_b128 v[20:23], v10
    s_waitcnt lgkmcnt(0)
    buffer_store_dwordx4 v[20:23], v53, s[12:15], s30 offen offset:64 sc1
    v_lshlrev_b32 v226, 6, v1
    s_barrier
    s_branch L_kb_entry
L_ka_spare:
    s_sub_u32 s19, s2, 224
    s_and_b32 s19, s19, 0xf8
    s_add_u32 s19, s19, s43
    v_lshlrev_b32 v8, 7, v0
    s_waitcnt lgkmcnt(0)
    s_mov_b32 s24, s44
    s_mov_b32 s25, s45
    s_mov_b32 s26, 0x380
    s_mov_b32 s27, 0x20000
    buffer_load_dword v16, v8, s[24:27], 0 offen
    s_and_b32 s30, s2, 7
    s_cmp_ge_u32 s19, 56
    s_cbranch_scc1 L_xt_da
    s_cmp_ge_u32 s19, 28
    s_cselect_b32 s31, 28, 0
    s_cselect_b32 s24, s48, s46
    s_cselect_b32 s25, s49, s47
    s_sub_u32 s29, s19, s31
    s_mul_i32 s29, s29, 57344
    s_mul_i32 s30, s30, 448
    s_and_b32 s30, s30, 0xffffff80
    s_add_u32 s29, s29, s30
    v_lshrrev_b32 v8, 2, v1
    v_mul_u32_u24 v8, 3584, v8
    v_and_b32 v9, 3, v1
    v_lshl_add_u32 v8, v9, 7, v8
    s_branch L_xt_goa
L_xt_da:
    s_mov_b32 s24, s50
    s_mov_b32 s25, s51
    s_sub_u32 s29, s19, 56
    s_lshl_b32 s29, s29, 13
    s_mul_i32 s30, s30, 200704
    s_add_u32 s29, s29, s30
    s_cmp_ge_u32 s19, 81
    s_cselect_b32 s29, 0x7ff00000, s29
    v_lshlrev_b32 v8, 7, v1
L_xt_goa:
    v_add_u32 v8, s29, v8
    s_mov_b32 s26, 0x188000
    s_mov_b32 s27, 0x20000
    buffer_load_dword v11, v8, s[24:27], 0 offen
    s_add_u32 s19, s19, 32
    s_cmp_ge_u32 s19, 56
    s_cbranch_scc1 L_ka_end
    s_and_b32 s30, s2, 7
    s_cmp_ge_u32 s19, 56
    s_cbranch_scc1 L_xt_db
    s_cmp_ge_u32 s19, 28
    s_cselect_b32 s31, 28, 0
    s_cselect_b32 s24, s48, s46
    s_cselect_b32 s25, s49, s47
    s_sub_u32 s29, s19, s31
    s_mul_i32 s29, s29, 57344
    s_mul_i32 s30, s30, 448
    s_and_b32 s30, s30, 0xffffff80
    s_add_u32 s29, s29, s30
    v_lshrrev_b32 v8, 2, v1
    v_mul_u32_u24 v8, 3584, v8
    v_and_b32 v9, 3, v1
    v_lshl_add_u32 v8, v9, 7, v8
    s_branch L_xt_gob
L_xt_db:
    s_mov_b32 s24, s50
    s_mov_b32 s25, s51
    s_sub_u32 s29, s19, 56
    s_lshl_b32 s29, s29, 13
    s_mul_i32 s30, s30, 200704
    s_add_u32 s29, s29, s30
    s_cmp_ge_u32 s19, 81
    s_cselect_b32 s29, 0x7ff00000, s29
    v_lshlrev_b32 v8, 7, v1
L_xt_gob:
    v_add_u32 v8, s29, v8
    s_mov_b32 s26, 0x188000
    s_mov_b32 s27, 0x20000
    buffer_load_dword v12, v8, s[24:27], 0 offen
    s_endpgm
L_ka_end:
    s_endpgm
L_kb_entry:
    s_cmp_ge_u32 s2, 184
    s_cbranch_scc1 L_kb_warm
    s_setprio 0
    s_load_dwordx2 s[20:21], s[0:1], 96
    s_load_dwordx2 s[4:5], s[0:1], 0
    s_load_dwordx8 s[8:15], s[0:1], 48
    s_load_dwordx4 s[16:19], s[0:1], 80
    s_mov_b32 s28, s43
    v_lshlrev_b32 v4, 4, v1
    s_cmp_ge_u32 s2, 128
    s_cbranch_scc1 L_kb_ffn
    s_and_b32 s29, s2, 31
    s_bfe_u32 s30, s2, 0x10005
    s_lshr_b32 s31, s2, 6
    s_lshl_b32 s32, s31, 5
    s_add_u32 s32, s32, s29
    s_sub_u32 s33, 32, s29
    s_and_b32 s33, s33, 31
    s_cmp_eq_u32 s31, 0
    s_cselect_b32 s29, s29, s33
    s_lshl_b32 s33, s30, 10
    s_add_u32 s33, s33, s32
    s_lshl_b32 s34, s28, 7
    s_add_u32 s34, s34, s33
    s_mul_i32 s35, s34, 896
    v_and_b32 v5, 31, v1
    v_lshrrev_b32 v6, 5, v1
    v_cmp_gt_u32 vcc, 28, v5
    v_lshlrev_b32 v9, 4, v5
    v_mov_b32 v10, 0x7ff00000
    v_mul_u32_u24 v11, 57344, v6
    v_cndmask_b32 v10, v10, v9, vcc
    v_add_u32 v10, v10, v11
    s_mul_i32 s38, s28, 3616
    s_add_u32 s38, s38, 57344
    v_mul_u32_u24 v7, 1808, v6
    v_lshl_add_u32 v7, v5, 5, v7
    v_add_u32 v7, s38, v7
    s_lshl_b32 s38, s28, 4
    s_add_u32 s38, s38, 93952
    v_lshl_add_u32 v120, v6, 3, s38
    s_mov_b32 s43, 0xffff0000
    s_lshl_b32 s53, s2, 7
    s_add_u32 s53, s53, 3145728
    s_waitcnt lgkmcnt(0)
    s_mov_b32 s44, s16
    s_mov_b32 s45, s17
    s_mov_b32 s46, 0x1c0000
    s_mov_b32 s47, 0x20000
    s_mov_b32 s24, s20
    s_mov_b32 s25, s21
    s_mov_b32 s26, 0x10000000
    s_mov_b32 s27, 0x20000
    s_cmp_eq_u32 s28, 7
    s_cbranch_scc1 L_p2_w7
    s_mul_i32 s36, s29, 57856
    s_lshl_b32 s37, s28, 7
    s_add_u32 s36, s36, s37
    s_lshl_b32 s42, s28, 6
    v_lshl_add_u32 v13, v3, 3, s42
    v_mul_u32_u24 v14, 1040, v2
    v_add_u32 v14, 140288, v14
    v_add_u32 v121, v14, v13
    v_sub_u32 v122, v14, v13
    v_add_u32 v123, 156928, v13
    v_sub_u32 v124, 156928, v13
    ds_read_b64 v[182:183], v121 offset:0
    ds_read_b64 v[186:187], v122 offset:888
    ds_read_b32 v190, v122 offset:896
    ds_read_b64 v[184:185], v121 offset:32
    ds_read_b64 v[188:189], v122 offset:856
    ds_read_b32 v191, v122 offset:864
    ds_read_b64 v[192:193], v123 offset:0
    ds_read_b64 v[196:197], v124 offset:888
    ds_read_b32 v200, v124 offset:896
    ds_read_b64 v[194:195], v123 offset:32
    ds_read_b64 v[198:199], v124 offset:856
    ds_read_b32 v201, v124 offset:864
    ds_read_u16 v202, v14 offset:448
    v_mov_b32 v125, 156928
    ds_read_u16 v203, v125 offset:448
    v_cmp_eq_u32 s[40:41], 0, v13
    s_lshl_b32 s37, s28, 13
    v_lshl_add_u32 v9, v2, 6, s33
    v_cvt_f32_u32 v9, v9
    v_mul_f32 v9, 0x3a000000, v9
    v_lshlrev_b32 v8, 3, v3
    v_cvt_f32_u32 v8, v8
    v_mul_f32 v8, v8, v9
    v_cos_f32 v64, v8
    v_sin_f32 v72, v8
    v_add_f32 v8, v8, v9
    v_cos_f32 v65, v8
    v_sin_f32 v73, v8
    v_add_f32 v8, v8, v9
    v_cos_f32 v66, v8
    v_sin_f32 v74, v8
    v_add_f32 v8, v8, v9
    v_cos_f32 v67, v8
    v_sin_f32 v75, v8
    v_add_f32 v8, v8, v9
    v_cos_f32 v68, v8
    v_sin_f32 v76, v8
    v_add_f32 v8, v8, v9
    v_cos_f32 v69, v8
    v_sin_f32 v77, v8
    v_add_f32 v8, v8, v9
    v_cos_f32 v70, v8
    v_sin_f32 v78, v8
    v_add_f32 v8, v8, v9
    v_cos_f32 v71, v8
    v_sin_f32 v79, v8
    s_lshl_b32 s55, s28, 11
    s_add_u32 s55, s55, 4063232
    s_mov_b32 exec_hi, 0
    buffer_load_dwordx2 v[228:229], v226, s[24:27], s55 offen sc1
    s_mov_b32 exec_hi, -1
    v_lshrrev_b32 v4, 3, v1
    v_mul_u32_u24 v4, 896, v4
    v_lshlrev_b32 v8, 1, v3
    v_and_b32 v8, 2, v8
    v_and_b32 v9, 7, v1
    v_xor_b32 v8, v8, v9
    v_lshl_add_u32 v4, v8, 4, v4
    v_xor_b32 v11, 64, v4
    v_cvt_pk_bf16_f32 v16, v64, v65
    v_cvt_pk_bf16_f32 v20, v72, v73
    v_cvt_pk_bf16_f32 v17, v66, v67
    v_cvt_pk_bf16_f32 v21, v74, v75
    v_cvt_pk_bf16_f32 v18, v68, v69
    v_cvt_pk_bf16_f32 v22, v76, v77
    v_cvt_pk_bf16_f32 v19, v70, v71
    v_cvt_pk_bf16_f32 v23, v78, v79
    s_cmp_gt_u32 s32, 32
    s_cselect_b32 s39, 0x80008000, 0
    s_xor_b32 s42, s39, 0x80008000
    v_xor_b32 v24, s39, v20
    v_xor_b32 v28, s42, v16
    v_xor_b32 v25, s39, v21
    v_xor_b32 v29, s42, v17
    v_xor_b32 v26, s39, v22
    v_xor_b32 v30, s42, v18
    v_xor_b32 v27, s39, v23
    v_xor_b32 v31, s42, v19
    s_cmp_lg_u32 s29, 0
    s_cbranch_scc1 L_p2_nospecial
    s_cmp_eq_u32 s32, 0
    s_cbranch_scc1 L_p2_t0
    v_mov_b32 v24, v16
    v_mov_b32 v28, v20
    v_mov_b32 v16, 0
    v_mov_b32 v20, 0
    v_mov_b32 v25, v17
    v_mov_b32 v29, v21
    v_mov_b32 v17, 0
    v_mov_b32 v21, 0
    v_mov_b32 v26, v18
    v_mov_b32 v30, v22
    v_mov_b32 v18, 0
    v_mov_b32 v22, 0
    v_mov_b32 v27, v19
    v_mov_b32 v31, v23
    v_mov_b32 v19, 0
    v_mov_b32 v23, 0
    s_branch L_p2_nospecial
L_p2_t0:
    v_mov_b32 v24, 0
    v_mov_b32 v28, 0
    v_mov_b32 v25, 0
    v_mov_b32 v29, 0
    v_mov_b32 v26, 0
    v_mov_b32 v30, 0
    v_mov_b32 v27, 0
    v_mov_b32 v31, 0
L_p2_nospecial:
    v_lshrrev_b32 v12, 2, v2
    v_lshlrev_b32 v12, 7, v12
    v_lshl_add_u32 v12, v3, 10, v12
    v_bfe_u32 v13, v2, 1, 1
    v_bfe_u32 v14, v2, 3, 1
    v_lshl_add_u32 v13, v14, 1, v13
    v_and_b32 v14, 1, v3
    v_lshl_add_u32 v13, v14, 2, v13
    v_lshl_add_u32 v12, v13, 4, v12
    v_and_b32 v14, 1, v2
    v_lshl_add_u32 v12, v14, 3, v12
    v_add_u32 v12, s37, v12
    v_xor_b32 v126, 32, v12
    v_xor_b32 v118, 64, v12
    v_xor_b32 v119, 0x60, v12
    v_lshl_add_u32 v117, v1, 4, s37
    s_waitcnt vmcnt(0)
    s_mov_b32 s63, 0
L_tagp:
    v_cmp_ne_u32 vcc, 0, v224
    s_cbranch_vccnz L_tagokp
    s_mov_b32 s56, s18
    s_mov_b32 s57, s19
    s_mov_b32 s58, 0x100
    s_mov_b32 s59, 0x20000
    buffer_load_dwordx2 v[224:225], off, s[56:59], 0 sc1
    s_add_u32 s63, s63, 1
    s_waitcnt vmcnt(0)
    s_cmp_lt_u32 s63, 0x40000
    s_cbranch_scc1 L_tagp
L_tagokp:
    s_mov_b32 s63, 0
    s_mov_b32 exec_hi, 0
    s_branch L_s1cp
L_s1p:
    buffer_load_dwordx2 v[228:229], v226, s[24:27], s55 offen sc1
    s_add_u32 s63, s63, 1
    s_waitcnt vmcnt(0)
L_s1cp:
    v_cmp_ne_u64 vcc, v[228:229], v[224:225]
    s_and_b64 exec, exec, vcc
    s_cbranch_scc0 L_s1dp
    s_cmp_lt_u32 s63, 0x40000
    s_cbranch_scc1 L_s1p
L_s1dp:
    s_mov_b64 exec, -1
    s_add_u32 m0, s37, 0
    s_add_u32 s54, s36, 0
    buffer_load_dwordx4 v4, s[24:27], s54 offen sc1 lds
    s_add_u32 m0, s37, 1024
    s_add_u32 s54, s36, 7168
    buffer_load_dwordx4 v11, s[24:27], s54 offen sc1 lds
    s_add_u32 m0, s37, 2048
    s_add_u32 s54, s36, 14336
    buffer_load_dwordx4 v4, s[24:27], s54 offen sc1 lds
    s_add_u32 m0, s37, 3072
    s_add_u32 s54, s36, 21504
    buffer_load_dwordx4 v11, s[24:27], s54 offen sc1 lds
    s_add_u32 m0, s37, 4096
    s_add_u32 s54, s36, 28928
    buffer_load_dwordx4 v4, s[24:27], s54 offen sc1 lds
    s_add_u32 m0, s37, 5120
    s_add_u32 s54, s36, 36096
    buffer_load_dwordx4 v11, s[24:27], s54 offen sc1 lds
    s_add_u32 m0, s37, 6144
    s_add_u32 s54, s36, 43264
    buffer_load_dwordx4 v4, s[24:27], s54 offen sc1 lds
    s_add_u32 m0, s37, 7168
    s_add_u32 s54, s36, 50432
    buffer_load_dwordx4 v11, s[24:27], s54 offen sc1 lds
    s_lshl_b32 s42, s28, 7
    v_lshl_add_u32 v13, v3, 4, s42
    v_mul_u32_u24 v14, 1808, v2
    v_add_u32 v14, 57344, v14
    v_sub_u32 v15, v14, v13
    v_add_u32 v15, 1716, v15
    v_add_u32 v13, v13, v14
    v_add_u32 v9, 76, v15
    v_add_u32 v8, 896, v14
    v_cndmask_b32 v14, v9, v8, s[40:41]
    s_lshl_b32 s42, s28, 6
    s_add_u32 s42, s42, 86528
    v_mul_u32_u24 v127, 464, v2
    v_lshl_add_u32 v127, v3, 4, v127
    v_add_u32 v127, s42, v127
    s_waitcnt lgkmcnt(0)
    v_lshlrev_b32 v144, 16, v182
    v_and_b32 v145, s43, v182
    v_lshlrev_b32 v146, 16, v183
    v_and_b32 v147, s43, v183
    v_cndmask_b32 v190, v190, v202, s[40:41]
    v_lshlrev_b32 v148, 16, v190
    v_and_b32 v149, s43, v187
    v_lshlrev_b32 v150, 16, v187
    v_and_b32 v151, s43, v186
    v_lshlrev_b32 v152, 16, v184
    v_and_b32 v153, s43, v184
    v_lshlrev_b32 v154, 16, v185
    v_and_b32 v155, s43, v185
    v_lshlrev_b32 v156, 16, v191
    v_and_b32 v157, s43, v189
    v_lshlrev_b32 v158, 16, v189
    v_and_b32 v159, s43, v188
    v_lshlrev_b32 v160, 16, v192
    v_and_b32 v161, s43, v192
    v_lshlrev_b32 v162, 16, v193
    v_and_b32 v163, s43, v193
    v_cndmask_b32 v200, v200, v203, s[40:41]
    v_lshlrev_b32 v164, 16, v200
    v_and_b32 v165, s43, v197
    v_lshlrev_b32 v166, 16, v197
    v_and_b32 v167, s43, v196
    v_lshlrev_b32 v168, 16, v194
    v_and_b32 v169, s43, v194
    v_lshlrev_b32 v170, 16, v195
    v_and_b32 v171, s43, v195
    v_lshlrev_b32 v172, 16, v201
    v_and_b32 v173, s43, v199
    v_lshlrev_b32 v174, 16, v199
    v_and_b32 v175, s43, v198
    v_mov_b32 v125, v144
    v_add_f32 v182, v144, v148
    v_sub_f32 v148, v144, v148
    v_mul_f32 v144, 0.5, v182
    v_mul_f32 v148, 0.5, v148
    v_add_f32 v182, v145, v149
    v_sub_f32 v149, v145, v149
    v_mul_f32 v145, 0.5, v182
    v_mul_f32 v149, 0.5, v149
    v_add_f32 v182, v146, v150
    v_sub_f32 v150, v146, v150
    v_mul_f32 v146, 0.5, v182
    v_mul_f32 v150, 0.5, v150
    v_add_f32 v182, v147, v151
    v_sub_f32 v151, v147, v151
    v_mul_f32 v147, 0.5, v182
    v_mul_f32 v151, 0.5, v151
    v_add_f32 v182, v152, v156
    v_sub_f32 v156, v152, v156
    v_mul_f32 v152, 0.5, v182
    v_mul_f32 v156, 0.5, v156
    v_add_f32 v182, v153, v157
    v_sub_f32 v157, v153, v157
    v_mul_f32 v153, 0.5, v182
    v_mul_f32 v157, 0.5, v157
    v_add_f32 v182, v154, v158
    v_sub_f32 v158, v154, v158
    v_mul_f32 v154, 0.5, v182
    v_mul_f32 v158, 0.5, v158
    v_add_f32 v182, v155, v159
    v_sub_f32 v159, v155, v159
    v_mul_f32 v155, 0.5, v182
    v_mul_f32 v159, 0.5, v159
    s_mov_b32 s55, 0
L_p2_scan:
    s_waitcnt vmcnt(0)
    ds_read_b32 v64, v117 offset:0
    ds_read_b32 v65, v117 offset:1024
    ds_read_b32 v66, v117 offset:2048
    ds_read_b32 v67, v117 offset:3072
    ds_read_b32 v68, v117 offset:4096
    ds_read_b32 v69, v117 offset:5120
    ds_read_b32 v70, v117 offset:6144
    ds_read_b32 v71, v117 offset:7168
    s_add_u32 s55, s55, 1
    s_waitcnt lgkmcnt(0)
    v_max3_u32 v72, v64, v65, v66
    v_max3_u32 v73, v67, v68, v69
    v_max3_u32 v72, v72, v70, v71
    v_max_u32 v72, v72, v73
    v_cmp_eq_u32 vcc, -1, v72
    s_cbranch_vccz L_p2_have
    s_cmp_ge_u32 s55, 0x40000
    s_cbranch_scc1 L_p2_have
    v_cmp_eq_u32 vcc, -1, v64
    s_and_b64 exec, exec, vcc
    s_cbranch_scc0 L_p2_sk0
    s_add_u32 m0, s37, 0
    s_add_u32 s54, s36, 0
    buffer_load_dwordx4 v4, s[24:27], s54 offen sc1 lds
L_p2_sk0:
    s_mov_b64 exec, -1
    v_cmp_eq_u32 vcc, -1, v65
    s_and_b64 exec, exec, vcc
    s_cbranch_scc0 L_p2_sk1
    s_add_u32 m0, s37, 1024
    s_add_u32 s54, s36, 7168
    buffer_load_dwordx4 v11, s[24:27], s54 offen sc1 lds
L_p2_sk1:
    s_mov_b64 exec, -1
    v_cmp_eq_u32 vcc, -1, v66
    s_and_b64 exec, exec, vcc
    s_cbranch_scc0 L_p2_sk2
    s_add_u32 m0, s37, 2048
    s_add_u32 s54, s36, 14336
    buffer_load_dwordx4 v4, s[24:27], s54 offen sc1 lds
L_p2_sk2:
    s_mov_b64 exec, -1
    v_cmp_eq_u32 vcc, -1, v67
    s_and_b64 exec, exec, vcc
    s_cbranch_scc0 L_p2_sk3
    s_add_u32 m0, s37, 3072
    s_add_u32 s54, s36, 21504
    buffer_load_dwordx4 v11, s[24:27], s54 offen sc1 lds
L_p2_sk3:
    s_mov_b64 exec, -1
    v_cmp_eq_u32 vcc, -1, v68
    s_and_b64 exec, exec, vcc
    s_cbranch_scc0 L_p2_sk4
    s_add_u32 m0, s37, 4096
    s_add_u32 s54, s36, 28928
    buffer_load_dwordx4 v4, s[24:27], s54 offen sc1 lds
L_p2_sk4:
    s_mov_b64 exec, -1
    v_cmp_eq_u32 vcc, -1, v69
    s_and_b64 exec, exec, vcc
    s_cbranch_scc0 L_p2_sk5
    s_add_u32 m0, s37, 5120
    s_add_u32 s54, s36, 36096
    buffer_load_dwordx4 v11, s[24:27], s54 offen sc1 lds
L_p2_sk5:
    s_mov_b64 exec, -1
    v_cmp_eq_u32 vcc, -1, v70
    s_and_b64 exec, exec, vcc
    s_cbranch_scc0 L_p2_sk6
    s_add_u32 m0, s37, 6144
    s_add_u32 s54, s36, 43264
    buffer_load_dwordx4 v4, s[24:27], s54 offen sc1 lds
L_p2_sk6:
    s_mov_b64 exec, -1
    v_cmp_eq_u32 vcc, -1, v71
    s_and_b64 exec, exec, vcc
    s_cbranch_scc0 L_p2_sk7
    s_add_u32 m0, s37, 7168
    s_add_u32 s54, s36, 50432
    buffer_load_dwordx4 v11, s[24:27], s54 offen sc1 lds
L_p2_sk7:
    s_mov_b64 exec, -1
    s_branch L_p2_scan
L_p2_have:
    ds_read_b64_tr_b16 v[64:65], v12 offset:0
    ds_read_b64_tr_b16 v[66:67], v12 offset:512
    ds_read_b64_tr_b16 v[68:69], v126 offset:0
    ds_read_b64_tr_b16 v[70:71], v126 offset:512
    ds_read_b64_tr_b16 v[72:73], v118 offset:0
    ds_read_b64_tr_b16 v[74:75], v118 offset:512
    ds_read_b64_tr_b16 v[76:77], v119 offset:0
    ds_read_b64_tr_b16 v[78:79], v119 offset:512
    s_waitcnt lgkmcnt(6)
    v_mfma_f32_16x16x32_bf16 v[32:35], v[64:67], v[16:19], v[144:147]
    s_waitcnt lgkmcnt(4)
    v_mfma_f32_16x16x32_bf16 v[36:39], v[68:71], v[20:23], v[148:151]
    s_waitcnt lgkmcnt(2)
    v_mfma_f32_16x16x32_bf16 v[40:43], v[72:75], v[16:19], v[152:155]
    s_waitcnt lgkmcnt(0)
    v_mfma_f32_16x16x32_bf16 v[44:47], v[76:79], v[20:23], v[156:159]
    ds_read_b64_tr_b16 v[80:81], v12 offset:4096
    ds_read_b64_tr_b16 v[82:83], v12 offset:4608
    ds_read_b64_tr_b16 v[84:85], v126 offset:4096
    ds_read_b64_tr_b16 v[86:87], v126 offset:4608
    ds_read_b64_tr_b16 v[88:89], v118 offset:4096
    ds_read_b64_tr_b16 v[90:91], v118 offset:4608
    ds_read_b64_tr_b16 v[92:93], v119 offset:4096
    ds_read_b64_tr_b16 v[94:95], v119 offset:4608
    s_waitcnt lgkmcnt(6)
    v_mfma_f32_16x16x32_bf16 v[32:35], v[80:83], v[24:27], v[32:35]
    s_waitcnt lgkmcnt(4)
    v_mfma_f32_16x16x32_bf16 v[36:39], v[84:87], v[28:31], v[36:39]
    s_waitcnt lgkmcnt(2)
    v_mfma_f32_16x16x32_bf16 v[40:43], v[88:91], v[24:27], v[40:43]
    s_waitcnt lgkmcnt(0)
    v_mfma_f32_16x16x32_bf16 v[44:47], v[92:95], v[28:31], v[44:47]
    s_nop 3
    v_add_f32 v128, v32, v36
    v_add_f32 v129, v33, v37
    v_add_f32 v130, v34, v38
    v_add_f32 v131, v35, v39
    v_sub_f32 v132, v32, v36
    v_sub_f32 v133, v33, v37
    v_sub_f32 v134, v34, v38
    v_sub_f32 v135, v35, v39
    v_cndmask_b32 v128, v128, v125, s[40:41]
    v_pk_mul_f32 v[178:179], v[128:129], v[128:129]
    v_pk_mul_f32 v[180:181], v[128:129], v[160:161]
    v_pk_add_f32 v[176:177], v[128:129], v[130:131]
    v_pk_fma_f32 v[178:179], v[130:131], v[130:131], v[178:179]
    v_pk_fma_f32 v[180:181], v[130:131], v[162:163], v[180:181]
    v_pk_add_f32 v[176:177], v[176:177], v[132:133]
    v_pk_fma_f32 v[178:179], v[132:133], v[132:133], v[178:179]
    v_pk_fma_f32 v[180:181], v[132:133], v[164:165], v[180:181]
    v_pk_add_f32 v[176:177], v[176:177], v[134:135]
    v_pk_fma_f32 v[178:179], v[134:135], v[134:135], v[178:179]
    v_pk_fma_f32 v[180:181], v[134:135], v[166:167], v[180:181]
    v_add_f32 v136, v40, v44
    v_add_f32 v137, v41, v45
    v_add_f32 v138, v42, v46
    v_add_f32 v139, v43, v47
    v_sub_f32 v140, v40, v44
    v_sub_f32 v141, v41, v45
    v_sub_f32 v142, v42, v46
    v_sub_f32 v143, v43, v47
    v_pk_add_f32 v[176:177], v[176:177], v[136:137]
    v_pk_fma_f32 v[178:179], v[136:137], v[136:137], v[178:179]
    v_pk_fma_f32 v[180:181], v[136:137], v[168:169], v[180:181]
    v_pk_add_f32 v[176:177], v[176:177], v[138:139]
    v_pk_fma_f32 v[178:179], v[138:139], v[138:139], v[178:179]
    v_pk_fma_f32 v[180:181], v[138:139], v[170:171], v[180:181]
    v_pk_add_f32 v[176:177], v[176:177], v[140:141]
    v_pk_fma_f32 v[178:179], v[140:141], v[140:141], v[178:179]
    v_pk_fma_f32 v[180:181], v[140:141], v[172:173], v[180:181]
    v_pk_add_f32 v[176:177], v[176:177], v[142:143]
    v_pk_fma_f32 v[178:179], v[142:143], v[142:143], v[178:179]
    v_pk_fma_f32 v[180:181], v[142:143], v[174:175], v[180:181]
    v_add_f32 v182, v176, v177
    v_add_f32 v183, v178, v179
    v_add_f32 v184, v180, v181
    ds_write_b128 v127, v[182:185]
    v_cmp_u_f32 vcc, v182, v183
    s_cbranch_vccz L_p2_clean
    s_add_u32 s54, s55, 0x1000
    s_mov_b32 s55, s54
    s_cmp_ge_u32 s55, 0x40000
    s_cbranch_scc1 L_p2_clean
    s_add_u32 m0, s37, 0
    s_add_u32 s54, s36, 0
    buffer_load_dwordx4 v4, s[24:27], s54 offen sc1 lds
    s_add_u32 m0, s37, 1024
    s_add_u32 s54, s36, 7168
    buffer_load_dwordx4 v11, s[24:27], s54 offen sc1 lds
    s_add_u32 m0, s37, 2048
    s_add_u32 s54, s36, 14336
    buffer_load_dwordx4 v4, s[24:27], s54 offen sc1 lds
    s_add_u32 m0, s37, 3072
    s_add_u32 s54, s36, 21504
    buffer_load_dwordx4 v11, s[24:27], s54 offen sc1 lds
    s_add_u32 m0, s37, 4096
    s_add_u32 s54, s36, 28928
    buffer_load_dwordx4 v4, s[24:27], s54 offen sc1 lds
    s_add_u32 m0, s37, 5120
    s_add_u32 s54, s36, 36096
    buffer_load_dwordx4 v11, s[24:27], s54 offen sc1 lds
    s_add_u32 m0, s37, 6144
    s_add_u32 s54, s36, 43264
    buffer_load_dwordx4 v4, s[24:27], s54 offen sc1 lds
    s_add_u32 m0, s37, 7168
    s_add_u32 s54, s36, 50432
    buffer_load_dwordx4 v11, s[24:27], s54 offen sc1 lds
    s_branch L_p2_scan
L_p2_clean:
    s_waitcnt lgkmcnt(0)
    s_barrier
    ds_write_b128 v13, v[128:131] offset:0
    ds_write_b32 v14, v132
    ds_write_b32 v15, v133 offset:72
    ds_write2_b32 v15, v134, v135 offset0:17 offset1:16
    ds_write_b128 v13, v[136:139] offset:64
    ds_write2_b32 v15, v140, v141 offset0:3 offset1:2
    ds_write2_b32 v15, v142, v143 offset0:1 offset1:0
    s_waitcnt lgkmcnt(0)
    s_branch L_p2_k
L_p2_w7:
    s_setprio 3
    v_lshlrev_b32 v9, 4, v1
    v_add_u32 v9, 156928, v9
    ds_read_b128 v[16:19], v9
    s_mov_b32 s52, 0x3f803f80
    v_mov_b32 v123, 0
    v_mul_u32_u24 v127, 464, v2
    v_mul_u32_u24 v9, 112, v3
    v_add3_u32 v127, v127, v9, 0
    v_add_u32 v127, 86528, v127
    v_lshl_add_u32 v11, v2, 6, s33
    v_sub_u32 v121, 0xfff, v11
    v_lshlrev_b32 v122, 3, v2
    v_add_u32 v122, 93952, v122
    v_lshlrev_b32 v124, 2, v1
    s_mov_b32 s38, 0x3b124925
    v_cmp_gt_u32 s[40:41], 16, v1
    s_waitcnt lgkmcnt(0)
    v_dot2c_f32_bf16 v123, s52, v16
    v_dot2c_f32_bf16 v123, s52, v17
    v_dot2c_f32_bf16 v123, s52, v18
    v_dot2c_f32_bf16 v123, s52, v19
    s_nop 2
    v_add_f32_dpp v123, v123, v123 row_ror:8 row_mask:0xf bank_mask:0xf
    s_nop 1
    v_add_f32_dpp v123, v123, v123 row_ror:4 row_mask:0xf bank_mask:0xf
    s_nop 1
    v_add_f32_dpp v123, v123, v123 row_ror:2 row_mask:0xf bank_mask:0xf
    s_nop 1
    v_add_f32_dpp v123, v123, v123 row_ror:1 row_mask:0xf bank_mask:0xf
    s_nop 1
    v_mov_b32 v9, v123
    s_nop 1
    v_permlane16_swap_b32 v123, v9
    v_add_f32 v123, v123, v9
    v_mov_b32 v9, v123
    s_nop 1
    v_permlane32_swap_b32 v123, v9
    v_add_f32 v123, v123, v9
    s_barrier
    ds_read_b128 v[16:19], v127 offset:0
    ds_read_b128 v[20:23], v127 offset:16
    ds_read_b128 v[24:27], v127 offset:32
    ds_read_b128 v[28:31], v127 offset:48
    ds_read_b128 v[32:35], v127 offset:64
    ds_read_b128 v[36:39], v127 offset:80
    ds_read_b128 v[40:43], v127 offset:96
    s_waitcnt lgkmcnt(5)
    v_pk_add_f32 v[16:17], v[16:17], v[20:21]
    v_add_f32 v18, v18, v22
    s_waitcnt lgkmcnt(4)
    v_pk_add_f32 v[16:17], v[16:17], v[24:25]
    v_add_f32 v18, v18, v26
    s_waitcnt lgkmcnt(3)
    v_pk_add_f32 v[16:17], v[16:17], v[28:29]
    v_add_f32 v18, v18, v30
    s_waitcnt lgkmcnt(2)
    v_pk_add_f32 v[16:17], v[16:17], v[32:33]
    v_add_f32 v18, v18, v34
    s_waitcnt lgkmcnt(1)
    v_pk_add_f32 v[16:17], v[16:17], v[36:37]
    v_add_f32 v18, v18, v38
    s_waitcnt lgkmcnt(0)
    v_pk_add_f32 v[16:17], v[16:17], v[40:41]
    v_add_f32 v18, v18, v42
    v_mov_b32 v20, v16
    v_mov_b32 v21, v17
    v_mov_b32 v22, v18
    v_permlane16_swap_b32 v16, v20
    v_permlane16_swap_b32 v17, v21
    v_permlane16_swap_b32 v18, v22
    v_pk_add_f32 v[16:17], v[16:17], v[20:21]
    v_add_f32 v18, v18, v22
    v_mov_b32 v20, v16
    v_mov_b32 v21, v17
    v_mov_b32 v22, v18
    v_permlane32_swap_b32 v16, v20
    v_permlane32_swap_b32 v17, v21
    v_permlane32_swap_b32 v18, v22
    v_pk_add_f32 v[16:17], v[16:17], v[20:21]
    v_add_f32 v18, v18, v22
    v_mul_f32 v8, s38, v16
    v_mul_f32 v9, s38, v17
    v_fma_f32 v9, -v8, v8, v9
    v_max_f32 v9, 0, v9
    v_cvt_pk_bf16_f32 v8, v9, v8
    v_lshlrev_b32 v9, 16, v8
    v_add_f32 v9, 0x3727c5ac, v9
    v_cvt_pk_bf16_f32 v9, v9, v9
    v_and_b32 v9, s43, v9
    v_sqrt_f32 v9, v9
    v_and_b32 v8, s43, v8
    v_cvt_pk_bf16_f32 v13, v9, v8
    v_lshlrev_b32 v9, 16, v13
    v_rcp_f32 v9, v9
    v_fma_f32 v12, -v8, v123, v18
    v_mul_f32 v12, v12, v9
    v_add_f32 v14, 1.0, v9
    v_cvt_pk_bf16_f32 v12, v12, v12
    v_mul_f32 v15, -v8, v9
    v_ashrrev_i32 v11, 31, v12
    ds_write_b64 v122, v[14:15]
    v_or_b32 v11, 0x80000000, v11
    v_xor_b32 v12, v12, v11
    v_and_or_b32 v12, v12, s43, v121
    v_cndmask_b32 v12, v13, v12, s[40:41]
    s_mov_b32 exec_hi, 0
    buffer_store_dword v12, v124, s[24:27], s53 offen sc1
    s_mov_b32 exec_hi, -1
    s_waitcnt lgkmcnt(0)
L_p2_k:
    s_barrier
    ds_read_b128 v[96:99], v7 offset:0
    ds_read_b128 v[100:103], v7 offset:16
    ds_read_b128 v[104:107], v7 offset:896
    ds_read_b128 v[108:111], v7 offset:912
    ds_read_b64 v[14:15], v120
    s_waitcnt lgkmcnt(0)
    v_pk_fma_f32 v[96:97], v[96:97], v[14:15], v[14:15] op_sel:[0,0,1] op_sel_hi:[1,0,1]
    v_pk_fma_f32 v[98:99], v[98:99], v[14:15], v[14:15] op_sel:[0,0,1] op_sel_hi:[1,0,1]
    v_cvt_pk_bf16_f32 v48, v96, v97
    v_cvt_pk_bf16_f32 v49, v98, v99
    v_pk_fma_f32 v[100:101], v[100:101], v[14:15], v[14:15] op_sel:[0,0,1] op_sel_hi:[1,0,1]
    v_pk_fma_f32 v[102:103], v[102:103], v[14:15], v[14:15] op_sel:[0,0,1] op_sel_hi:[1,0,1]
    v_cvt_pk_bf16_f32 v50, v100, v101
    v_cvt_pk_bf16_f32 v51, v102, v103
    buffer_store_dwordx4 v[48:51], v10, s[44:47], s35 offen sc1
    v_pk_fma_f32 v[104:105], v[104:105], v[14:15], v[14:15] op_sel:[0,0,1] op_sel_hi:[1,0,1]
    v_pk_fma_f32 v[106:107], v[106:107], v[14:15], v[14:15] op_sel:[0,0,1] op_sel_hi:[1,0,1]
    v_cvt_pk_bf16_f32 v52, v104, v105
    v_cvt_pk_bf16_f32 v53, v106, v107
    v_pk_fma_f32 v[108:109], v[108:109], v[14:15], v[14:15] op_sel:[0,0,1] op_sel_hi:[1,0,1]
    v_pk_fma_f32 v[110:111], v[110:111], v[14:15], v[14:15] op_sel:[0,0,1] op_sel_hi:[1,0,1]
    v_cvt_pk_bf16_f32 v54, v108, v109
    v_cvt_pk_bf16_f32 v55, v110, v111
    buffer_store_dwordx4 v[52:55], v10, s[44:47], s35 offen offset:448 sc1
    s_waitcnt vmcnt(0)
    s_barrier
    s_cmp_lg_u32 s28, 0
    s_cbranch_scc1 L_p2_end
    s_mov_b64 exec, 1
    v_mov_b32 v12, 1
    s_add_u32 s53, s53, 16384
    buffer_store_dword v12, off, s[24:27], s53 sc1
L_p2_end:
    s_endpgm
L_kb_ffn:
    s_sub_u32 s29, s2, 128
    s_and_b32 s37, s29, 7
    s_lshr_b32 s38, s29, 3
    s_mul_i32 s39, s37, 7
    s_add_u32 s39, s39, s38
    s_cmp_eq_u32 s28, 7
    s_cbranch_scc1 L_f_poll
    s_cmp_lt_u32 s28, 4
    s_cbranch_scc1 L_f_comp
    v_lshrrev_b32 v5, 2, v1
    v_and_b32 v6, 3, v1
    v_lshrrev_b32 v7, 4, v1
    v_and_b32 v7, 2, v7
    v_xor_b32 v6, v6, v7
    s_cmp_eq_u32 s28, 5
    s_cselect_b32 s40, 1, 0
    v_xor_b32 v6, s40, v6
    s_cmp_eq_u32 s28, 6
    s_movk_i32 s41, 896
    s_cselect_b32 s41, s41, 3584
    s_cselect_b32 s42, 64, 114688
    s_cselect_b32 s43, 28672, 64
    v_mul_u32_u24 v5, s41, v5
    v_lshl_add_u32 v5, v6, 4, v5
    s_lshl_b32 s44, s41, 4
    v_add_u32 v6, s44, v5
    s_mul_i32 s43, s43, s39
    s_sub_u32 s44, s28, 4
    s_mul_i32 s44, s44, 28672
    s_add_u32 s44, s44, 16384
    s_waitcnt lgkmcnt(0)
    s_cmp_eq_u32 s28, 5
    s_cselect_b32 s48, s12, s10
    s_cselect_b32 s49, s13, s11
    s_cmp_eq_u32 s28, 6
    s_cselect_b32 s48, s14, s48
    s_cselect_b32 s49, s15, s49
    s_mov_b32 s50, 0x188000
    s_mov_b32 s51, 0x20000
    s_add_u32 s45, s44, 28672
    s_barrier
L_f_dma:
    s_mov_b32 m0, s44
    s_add_u32 s44, s44, 2048
    buffer_load_dwordx4 v5, s[48:51], s43 offen lds
    s_add_u32 m0, m0, 1024
    s_nop 0
    buffer_load_dwordx4 v6, s[48:51], s43 offen lds
    s_add_u32 s43, s43, s42
    s_cmp_lt_u32 s44, s45
    s_cbranch_scc1 L_f_dma
    v_mov_b32 v5, 15360
    v_mov_b32 v6, 1
    s_mov_b64 exec, 1
    s_waitcnt vmcnt(0)
    ds_add_u32 v5, v6
    s_waitcnt lgkmcnt(0)
    s_endpgm
L_f_comp:
    v_mov_b32 v6, 0
    v_mov_b32 v7, 15360
    ds_write_b32 v7, v6
    s_waitcnt lgkmcnt(0)
    s_barrier
    s_mov_b32 s24, s20
    s_mov_b32 s25, s21
    s_mov_b32 s26, 0x10000000
    s_mov_b32 s27, 0x20000
    v_lshrrev_b32 v8, 2, v2
    v_bfe_u32 v9, v2, 1, 1
    v_and_b32 v10, 1, v3
    v_and_b32 v13, 1, v2
    v_lshlrev_b32 v13, 3, v13
    v_lshl_add_u32 v11, v10, 1, v9
    v_xor_b32 v11, s28, v11
    v_lshl_add_u32 v14, v3, 3, v8
    v_lshl_add_u32 v14, v14, 6, v13
    v_lshl_add_u32 v14, v11, 4, v14
    v_mul_u32_u24 v11, 28672, v9
    s_movk_i32 s42, 16384
    v_add3_u32 v14, v14, v11, s42
    v_lshl_add_u32 v8, v10, 3, v8
    v_lshl_add_u32 v15, v8, 6, v13
    s_and_b32 s42, s28, 1
    v_xor_b32 v10, s42, v10
    v_lshl_add_u32 v10, v10, 1, v9
    v_lshl_add_u32 v15, v10, 4, v15
    v_lshrrev_b32 v10, 1, v3
    v_lshl_add_u32 v15, v10, 10, v15
    s_lshr_b32 s42, s28, 1
    s_lshl_b32 s42, s42, 11
    s_add_u32 s42, s42, 73728
    v_add_u32 v15, s42, v15
    v_and_b32 v8, 7, v2
    v_mul_u32_u24 v8, 1056, v8
    v_lshl_add_u32 v12, v3, 4, v8
    v_cmp_gt_u32 vcc, 8, v2
    v_lshlrev_b32 v6, 4, v2
    v_lshl_add_u32 v6, v3, 7, v6
    v_mov_b32 v8, 0x7ff00000
    v_cndmask_b32 v6, v8, v6, vcc
    s_lshl_b32 s42, s28, 8
    s_add_u32 s42, s42, 14336
    v_lshl_add_u32 v5, v2, 4, s42
    v_lshl_add_u32 v5, v3, 3, v5
    s_mul_i32 s44, s39, 14336
    s_lshl_b32 s42, s28, 9
    s_add_u32 s44, s44, s42
    s_add_u32 s44, s44, 3178496
    s_add_u32 s45, s44, 4096
    s_add_u32 s46, s44, 8192
    s_add_u32 s47, s44, 12288
    s_mov_b32 s42, 0xbfb8aa3b
    v_and_b32 v11, 7, v2
    v_lshlrev_b32 v11, 2, v11
L_f_wait:
    s_sleep 2
    ds_read_b32 v8, v7
    s_waitcnt lgkmcnt(0)
    v_cmp_ne_u32 vcc, 3, v8
    s_cbranch_vccnz L_f_wait
    ds_read_b64_tr_b16 v[64:65], v14 offset:0
    ds_read_b64_tr_b16 v[66:67], v14 offset:256
    ds_read_b64_tr_b16 v[68:69], v14 offset:2048
    ds_read_b64_tr_b16 v[70:71], v14 offset:2304
    ds_read_b64_tr_b16 v[72:73], v14 offset:4096
    ds_read_b64_tr_b16 v[74:75], v14 offset:4352
    ds_read_b64_tr_b16 v[76:77], v14 offset:6144
    ds_read_b64_tr_b16 v[78:79], v14 offset:6400
    ds_read_b64_tr_b16 v[80:81], v14 offset:8192
    ds_read_b64_tr_b16 v[82:83], v14 offset:8448
    ds_read_b64_tr_b16 v[84:85], v14 offset:10240
    ds_read_b64_tr_b16 v[86:87], v14 offset:10496
    ds_read_b64_tr_b16 v[88:89], v14 offset:12288
    ds_read_b64_tr_b16 v[90:91], v14 offset:12544
    ds_read_b64_tr_b16 v[92:93], v14 offset:14336
    ds_read_b64_tr_b16 v[94:95], v14 offset:14592
    ds_read_b64_tr_b16 v[96:97], v14 offset:16384
    ds_read_b64_tr_b16 v[98:99], v14 offset:16640
    ds_read_b64_tr_b16 v[100:101], v14 offset:18432
    ds_read_b64_tr_b16 v[102:103], v14 offset:18688
    ds_read_b64_tr_b16 v[104:105], v14 offset:20480
    ds_read_b64_tr_b16 v[106:107], v14 offset:20736
    ds_read_b64_tr_b16 v[108:109], v14 offset:22528
    ds_read_b64_tr_b16 v[110:111], v14 offset:22784
    ds_read_b64_tr_b16 v[112:113], v14 offset:24576
    ds_read_b64_tr_b16 v[114:115], v14 offset:24832
    ds_read_b64_tr_b16 v[116:117], v14 offset:26624
    ds_read_b64_tr_b16 v[118:119], v14 offset:26880
    ds_read_b64_tr_b16 v[36:37], v15 offset:0
    ds_read_b64_tr_b16 v[38:39], v15 offset:256
    ds_read_b64_tr_b16 v[40:41], v15 offset:4096
    ds_read_b64_tr_b16 v[42:43], v15 offset:4352
    ds_read_b64_tr_b16 v[44:45], v15 offset:8192
    ds_read_b64_tr_b16 v[46:47], v15 offset:8448
    ds_read_b64_tr_b16 v[48:49], v15 offset:12288
    ds_read_b64_tr_b16 v[50:51], v15 offset:12544
    ds_read_b64_tr_b16 v[52:53], v15 offset:16384
    ds_read_b64_tr_b16 v[54:55], v15 offset:16640
    ds_read_b64_tr_b16 v[56:57], v15 offset:20480
    ds_read_b64_tr_b16 v[58:59], v15 offset:20736
    ds_read_b64_tr_b16 v[60:61], v15 offset:24576
    ds_read_b64_tr_b16 v[62:63], v15 offset:24832
    v_mov_b32 v16, 0x3f803f80
    v_mov_b32 v17, 0x3f803f80
    v_mov_b32 v18, 0x3f803f80
    v_mov_b32 v19, 0x3f803f80
    s_waitcnt lgkmcnt(0)
    v_mfma_f32_16x16x32_bf16 v[128:131], v[64:67], v[16:19], 0
    v_mfma_f32_16x16x32_bf16 v[128:131], v[68:71], v[16:19], v[128:131]
    v_mfma_f32_16x16x32_bf16 v[128:131], v[72:75], v[16:19], v[128:131]
    v_mfma_f32_16x16x32_bf16 v[128:131], v[76:79], v[16:19], v[128:131]
    v_mfma_f32_16x16x32_bf16 v[128:131], v[80:83], v[16:19], v[128:131]
    v_mfma_f32_16x16x32_bf16 v[128:131], v[84:87], v[16:19], v[128:131]
    v_mfma_f32_16x16x32_bf16 v[128:131], v[88:91], v[16:19], v[128:131]
    v_mfma_f32_16x16x32_bf16 v[128:131], v[92:95], v[16:19], v[128:131]
    v_mfma_f32_16x16x32_bf16 v[128:131], v[96:99], v[16:19], v[128:131]
    v_mfma_f32_16x16x32_bf16 v[128:131], v[100:103], v[16:19], v[128:131]
    v_mfma_f32_16x16x32_bf16 v[128:131], v[104:107], v[16:19], v[128:131]
    v_mfma_f32_16x16x32_bf16 v[128:131], v[108:111], v[16:19], v[128:131]
    v_mfma_f32_16x16x32_bf16 v[128:131], v[112:115], v[16:19], v[128:131]
    v_mfma_f32_16x16x32_bf16 v[128:131], v[116:119], v[16:19], v[128:131]
    s_barrier
    ds_read_b32 v10, v11 offset:15424
    ds_read_b128 v[16:19], v12 offset:0
    ds_read_b128 v[20:23], v12 offset:64
    ds_read_b128 v[24:27], v12 offset:128
    ds_read_b128 v[28:31], v12 offset:192
    ds_read_b128 v[120:123], v12 offset:256
    s_waitcnt lgkmcnt(5)
    v_lshlrev_b32 v9, 16, v10
    v_and_b32 v10, 0xffff0000, v10
    v_add_f32 v9, 1.0, v9
    v_mul_f32 v132, -v10, v128
    v_mul_f32 v133, -v10, v129
    v_mul_f32 v134, -v10, v130
    v_mul_f32 v135, -v10, v131
    v_rcp_f32 v9, v9
    ds_read_b128 v[124:127], v12 offset:320
    s_waitcnt lgkmcnt(5)
    v_mfma_f32_16x16x32_bf16 v[32:35], v[64:67], v[16:19], v[132:135]
    ds_read_b128 v[16:19], v12 offset:384
    s_waitcnt lgkmcnt(5)
    v_mfma_f32_16x16x32_bf16 v[32:35], v[68:71], v[20:23], v[32:35]
    ds_read_b128 v[20:23], v12 offset:448
    s_waitcnt lgkmcnt(5)
    v_mfma_f32_16x16x32_bf16 v[32:35], v[72:75], v[24:27], v[32:35]
    ds_read_b128 v[24:27], v12 offset:512
    s_waitcnt lgkmcnt(5)
    v_mfma_f32_16x16x32_bf16 v[32:35], v[76:79], v[28:31], v[32:35]
    ds_read_b128 v[28:31], v12 offset:576
    s_waitcnt lgkmcnt(5)
    v_mfma_f32_16x16x32_bf16 v[32:35], v[80:83], v[120:123], v[32:35]
    v_mul_f32 v8, s42, v9
    v_mul_f32 v9, v9, v9
    ds_read_b128 v[120:123], v12 offset:640
    s_waitcnt lgkmcnt(5)
    v_mfma_f32_16x16x32_bf16 v[32:35], v[84:87], v[124:127], v[32:35]
    ds_read_b128 v[124:127], v12 offset:704
    s_waitcnt lgkmcnt(5)
    v_mfma_f32_16x16x32_bf16 v[32:35], v[88:91], v[16:19], v[32:35]
    ds_read_b128 v[16:19], v12 offset:768
    s_waitcnt lgkmcnt(5)
    v_mfma_f32_16x16x32_bf16 v[32:35], v[92:95], v[20:23], v[32:35]
    ds_read_b128 v[20:23], v12 offset:832
    s_waitcnt lgkmcnt(5)
    v_mfma_f32_16x16x32_bf16 v[32:35], v[96:99], v[24:27], v[32:35]
    s_waitcnt lgkmcnt(4)
    v_mfma_f32_16x16x32_bf16 v[32:35], v[100:103], v[28:31], v[32:35]
    s_waitcnt lgkmcnt(3)
    v_mfma_f32_16x16x32_bf16 v[32:35], v[104:107], v[120:123], v[32:35]
    s_waitcnt lgkmcnt(2)
    v_mfma_f32_16x16x32_bf16 v[32:35], v[108:111], v[124:127], v[32:35]
    s_waitcnt lgkmcnt(1)
    v_mfma_f32_16x16x32_bf16 v[32:35], v[112:115], v[16:19], v[32:35]
    s_waitcnt lgkmcnt(0)
    v_mfma_f32_16x16x32_bf16 v[32:35], v[116:119], v[20:23], v[32:35]
    s_nop 7
    v_permlane32_swap_b32 v32, v20
    v_permlane32_swap_b32 v33, v21
    v_permlane32_swap_b32 v34, v22
    v_permlane32_swap_b32 v35, v23
    v_mul_f32 v16, v8, v32
    v_mul_f32 v17, v8, v33
    v_mul_f32 v18, v8, v34
    v_mul_f32 v19, v8, v35
    v_exp_f32 v16, v16
    v_exp_f32 v17, v17
    v_exp_f32 v18, v18
    v_exp_f32 v19, v19
    v_mul_f32 v32, v32, v20
    v_mul_f32 v33, v33, v21
    v_mul_f32 v34, v34, v22
    v_mul_f32 v35, v35, v23
    v_add_f32 v16, 1.0, v16
    v_add_f32 v17, 1.0, v17
    v_add_f32 v18, 1.0, v18
    v_add_f32 v19, 1.0, v19
    v_rcp_f32 v16, v16
    v_rcp_f32 v17, v17
    v_rcp_f32 v18, v18
    v_rcp_f32 v19, v19
    v_mul_f32 v32, v32, v9
    v_mul_f32 v33, v33, v9
    v_mul_f32 v34, v34, v9
    v_mul_f32 v35, v35, v9
    s_mov_b32 exec_hi, 0
    v_mul_f32 v32, v32, v16
    v_mul_f32 v33, v33, v17
    v_mul_f32 v34, v34, v18
    v_mul_f32 v35, v35, v19
    v_cvt_pk_bf16_f32 v16, v32, v33
    v_cvt_pk_bf16_f32 v17, v34, v35
    ds_write_b64 v5, v[16:17]
    s_mov_b32 exec_hi, -1
    s_waitcnt lgkmcnt(0)
    s_barrier
    ds_read_b128 v[16:19], v4 offset:14336
    s_waitcnt lgkmcnt(0)
    v_mfma_f32_16x16x32_bf16 v[64:67], v[36:39], v[16:19], 0
    v_mfma_f32_16x16x32_bf16 v[68:71], v[40:43], v[16:19], 0
    v_mfma_f32_16x16x32_bf16 v[72:75], v[44:47], v[16:19], 0
    v_mfma_f32_16x16x32_bf16 v[76:79], v[48:51], v[16:19], 0
    v_mfma_f32_16x16x32_bf16 v[80:83], v[52:55], v[16:19], 0
    v_mfma_f32_16x16x32_bf16 v[84:87], v[56:59], v[16:19], 0
    v_mfma_f32_16x16x32_bf16 v[88:91], v[60:63], v[16:19], 0
    s_nop 1
    buffer_store_dwordx4 v[64:67], v6, s[24:27], s44 offen offset:0 sc1
    buffer_store_dwordx4 v[68:71], v6, s[24:27], s44 offen offset:2048 sc1
    buffer_store_dwordx4 v[72:75], v6, s[24:27], s45 offen offset:0 sc1
    buffer_store_dwordx4 v[76:79], v6, s[24:27], s45 offen offset:2048 sc1
    buffer_store_dwordx4 v[80:83], v6, s[24:27], s46 offen offset:0 sc1
    buffer_store_dwordx4 v[84:87], v6, s[24:27], s46 offen offset:2048 sc1
    buffer_store_dwordx4 v[88:91], v6, s[24:27], s47 offen offset:0 sc1
    s_waitcnt vmcnt(4)
    s_barrier
    s_endpgm
L_f_poll:
    s_setprio 3
    v_lshrrev_b32 v4, 2, v1
    v_lshlrev_b32 v4, 7, v4
    v_and_b32 v5, 3, v1
    v_lshl_add_u32 v4, v5, 4, v4
    s_mov_b32 s46, 0
    s_mov_b32 s47, 0
    v_and_b32 v6, 7, v1
    v_lshlrev_b32 v13, 2, v6
    v_cmp_gt_u32 vcc, 56, v1
    v_lshlrev_b32 v5, 4, v1
    v_mov_b32 v6, 0x7ff00000
    v_cndmask_b32 v6, v6, v5, vcc
    v_bfe_u32 v14, v1, 3, 1
    s_lshl_b32 s42, s39, 4
    v_lshl_add_u32 v14, v14, 3, s42
    v_mul_u32_u24 v24, 14336, v3
    v_lshl_add_u32 v24, v2, 4, v24
    v_add_u32 v25, 57344, v24
    v_add_u32 v26, 57344, v25
    v_add_u32 v27, 57344, v26
    s_lshl_b32 s52, s39, 8
    s_add_u32 s52, s52, 3178496
    s_add_u32 s53, s52, 229376
    s_add_u32 s54, s52, 458752
    s_add_u32 s55, s52, 688128
    v_mov_b32 v8, 0
    v_mov_b32 v9, 0
    v_mov_b32 v10, 0
    v_lshlrev_b32 v7, 12, v1
    v_lshlrev_b32 v19, 7, v1
    s_movk_i32 s44, 896
    s_mov_b32 s45, 0xffff0000
    s_waitcnt lgkmcnt(0)
    s_mov_b32 s24, s20
    s_mov_b32 s25, s21
    s_mov_b32 s26, 0x10000000
    s_mov_b32 s27, 0x20000
    s_mov_b32 s48, s16
    s_mov_b32 s49, s17
    s_mov_b32 s50, 0x1c0000
    s_mov_b32 s51, 0x20000
    s_barrier
    s_mov_b32 s62, 0x3e0000
    s_waitcnt vmcnt(0)
    s_mov_b32 s63, 0
L_tagf:
    v_cmp_ne_u32 vcc, 0, v224
    s_cbranch_vccnz L_tagokf
    s_mov_b32 s56, s18
    s_mov_b32 s57, s19
    s_mov_b32 s58, 0x100
    s_mov_b32 s59, 0x20000
    buffer_load_dwordx2 v[224:225], off, s[56:59], 0 sc1
    s_add_u32 s63, s63, 1
    s_waitcnt vmcnt(0)
    s_cmp_lt_u32 s63, 0x40000
    s_cbranch_scc1 L_tagf
L_tagokf:
    s_mov_b32 s63, 0
    s_mov_b64 exec, 0xff
L_s1f:
    s_sleep 4
    buffer_load_dwordx2 v[228:229], v226, s[24:27], s62 offen sc1
    s_add_u32 s63, s63, 1
    s_waitcnt vmcnt(0)
L_s1cf:
    v_cmp_ne_u64 vcc, v[228:229], v[224:225]
    s_and_b64 exec, exec, vcc
    s_cbranch_scc0 L_s1df
    s_cmp_lt_u32 s63, 0x40000
    s_cbranch_scc1 L_s1f
L_s1df:
    s_mov_b64 exec, -1
    s_mov_b32 s58, 0x300000
    s_mov_b32 s59, 0x301000
    s_mov_b32 s60, 0x302000
    s_mov_b32 s61, 0x303000
    s_mov_b32 s56, 0x304000
    s_mov_b32 s57, 0x306000
    s_mov_b64 exec, 0xf
L_f_p0:
    s_sleep 2
    buffer_load_dword v11, v7, s[24:27], s58 offen offset:3968 sc1
    s_add_u32 s47, s47, 1
    s_waitcnt vmcnt(0)
    v_cmp_ne_u32 vcc, 0, v11
    s_cbranch_vccnz L_f_p1
    s_cmp_lt_u32 s47, 0x40000
    s_cbranch_scc1 L_f_p0
L_f_p1:
    s_mov_b64 exec, -1
L_f_pk:
    buffer_load_dwordx4 v[64:67], v4, s[24:27], s58 offen offset:0 sc1
    buffer_load_dwordx4 v[68:71], v4, s[24:27], s58 offen offset:2048 sc1
    buffer_load_dwordx4 v[72:75], v4, s[24:27], s59 offen offset:0 sc1
    buffer_load_dwordx4 v[76:79], v4, s[24:27], s59 offen offset:2048 sc1
    buffer_load_dwordx4 v[80:83], v4, s[24:27], s60 offen offset:0 sc1
    buffer_load_dwordx4 v[84:87], v4, s[24:27], s60 offen offset:2048 sc1
    buffer_load_dwordx4 v[88:91], v4, s[24:27], s61 offen offset:0 sc1
    buffer_load_dwordx4 v[92:95], v4, s[24:27], s61 offen offset:2048 sc1
    s_add_u32 s47, s47, 1
.p2align 3
    s_waitcnt vmcnt(7)
    s_nop 0
    v_max3_u32 v8, v64, v65, v66
    v_med3_u32 v9, v64, v65, v66
    v_min3_u32 v10, v64, v65, v66
    v_min3_u32 v11, v10, v67, v67
    v_med3_u32 v10, v9, v10, v67
    v_med3_u32 v9, v8, v9, v67
    v_max_u32_e64 v8, v8, v67
    s_waitcnt vmcnt(6)
    s_nop 0
    v_min3_u32 v11, v11, v68, v69
    v_min3_u32 v11, v11, v70, v71
    v_med3_u32 v10, v9, v10, v68
    v_med3_u32 v9, v8, v9, v68
    v_max_u32_e64 v8, v8, v68
    v_med3_u32 v10, v9, v10, v69
    v_med3_u32 v9, v8, v9, v69
    v_max_u32_e64 v8, v8, v69
    v_med3_u32 v10, v9, v10, v70
    v_med3_u32 v9, v8, v9, v70
    v_max_u32_e64 v8, v8, v70
    v_med3_u32 v10, v9, v10, v71
    v_med3_u32 v9, v8, v9, v71
    v_max_u32_e64 v8, v8, v71
    s_waitcnt vmcnt(5)
    s_nop 0
    v_min3_u32 v11, v11, v72, v73
    v_min3_u32 v11, v11, v74, v75
    v_med3_u32 v10, v9, v10, v72
    v_med3_u32 v9, v8, v9, v72
    v_max_u32_e64 v8, v8, v72
    v_med3_u32 v10, v9, v10, v73
    v_med3_u32 v9, v8, v9, v73
    v_max_u32_e64 v8, v8, v73
    v_med3_u32 v10, v9, v10, v74
    v_med3_u32 v9, v8, v9, v74
    v_max_u32_e64 v8, v8, v74
    v_med3_u32 v10, v9, v10, v75
    v_med3_u32 v9, v8, v9, v75
    v_max_u32_e64 v8, v8, v75
    s_waitcnt vmcnt(4)
    s_nop 0
    v_min3_u32 v11, v11, v76, v77
    v_min3_u32 v11, v11, v78, v79
    v_med3_u32 v10, v9, v10, v76
    v_med3_u32 v9, v8, v9, v76
    v_max_u32_e64 v8, v8, v76
    v_med3_u32 v10, v9, v10, v77
    v_med3_u32 v9, v8, v9, v77
    v_max_u32_e64 v8, v8, v77
    v_med3_u32 v10, v9, v10, v78
    v_med3_u32 v9, v8, v9, v78
    v_max_u32_e64 v8, v8, v78
    v_med3_u32 v10, v9, v10, v79
    v_med3_u32 v9, v8, v9, v79
    v_max_u32_e64 v8, v8, v79
    s_waitcnt vmcnt(3)
    s_nop 0
    v_min3_u32 v11, v11, v80, v81
    v_min3_u32 v11, v11, v82, v83
    v_med3_u32 v10, v9, v10, v80
    v_med3_u32 v9, v8, v9, v80
    v_max_u32_e64 v8, v8, v80
    v_med3_u32 v10, v9, v10, v81
    v_med3_u32 v9, v8, v9, v81
    v_max_u32_e64 v8, v8, v81
    v_med3_u32 v10, v9, v10, v82
    v_med3_u32 v9, v8, v9, v82
    v_max_u32_e64 v8, v8, v82
    v_med3_u32 v10, v9, v10, v83
    v_med3_u32 v9, v8, v9, v83
    v_max_u32_e64 v8, v8, v83
    s_waitcnt vmcnt(2)
    s_nop 0
    v_min3_u32 v11, v11, v84, v85
    v_min3_u32 v11, v11, v86, v87
    v_med3_u32 v10, v9, v10, v84
    v_med3_u32 v9, v8, v9, v84
    v_max_u32_e64 v8, v8, v84
    v_med3_u32 v10, v9, v10, v85
    v_med3_u32 v9, v8, v9, v85
    v_max_u32_e64 v8, v8, v85
    v_med3_u32 v10, v9, v10, v86
    v_med3_u32 v9, v8, v9, v86
    v_max_u32_e64 v8, v8, v86
    v_med3_u32 v10, v9, v10, v87
    v_med3_u32 v9, v8, v9, v87
    v_max_u32_e64 v8, v8, v87
    s_waitcnt vmcnt(1)
    s_nop 0
    v_min3_u32 v11, v11, v88, v89
    v_min3_u32 v11, v11, v90, v91
    v_med3_u32 v10, v9, v10, v88
    v_med3_u32 v9, v8, v9, v88
    v_max_u32_e64 v8, v8, v88
    v_med3_u32 v10, v9, v10, v89
    v_med3_u32 v9, v8, v9, v89
    v_max_u32_e64 v8, v8, v89
    v_med3_u32 v10, v9, v10, v90
    v_med3_u32 v9, v8, v9, v90
    v_max_u32_e64 v8, v8, v90
    v_med3_u32 v10, v9, v10, v91
    v_med3_u32 v9, v8, v9, v91
    v_max_u32_e64 v8, v8, v91
    s_waitcnt vmcnt(0)
    s_nop 0
    v_min3_u32 v11, v11, v92, v93
    v_min3_u32 v11, v11, v94, v95
    v_med3_u32 v10, v9, v10, v92
    v_med3_u32 v9, v8, v9, v92
    v_max_u32_e64 v8, v8, v92
    v_med3_u32 v10, v9, v10, v93
    v_med3_u32 v9, v8, v9, v93
    v_max_u32_e64 v8, v8, v93
    v_med3_u32 v10, v9, v10, v94
    v_med3_u32 v9, v8, v9, v94
    v_max_u32_e64 v8, v8, v94
    v_med3_u32 v10, v9, v10, v95
    v_med3_u32 v9, v8, v9, v95
    v_max_u32_e64 v8, v8, v95
    v_cmp_eq_u32 vcc, 0, v11
    s_cbranch_vccz L_f_keys
    s_cmp_lt_u32 s47, 0x40000
    s_cbranch_scc1 L_f_pk
L_f_keys:
    buffer_load_dword v28, v19, s[24:27], s56 offen sc1
    buffer_load_dword v29, v19, s[24:27], s57 offen sc1
    v_max_u32_dpp v11, v8, v8 row_shr:1 row_mask:0xf bank_mask:0xf bound_ctrl:0
    s_nop 1
    v_max_u32_dpp v11, v11, v11 row_shr:2 row_mask:0xf bank_mask:0xf
    s_nop 1
    v_max_u32_dpp v11, v11, v11 row_shr:4 row_mask:0xf bank_mask:0xf
    s_nop 1
    v_max_u32_dpp v11, v11, v11 row_shr:8 row_mask:0xf bank_mask:0xf
    s_nop 1
    v_max_u32_dpp v11, v11, v11 row_bcast:15 row_mask:0xa bank_mask:0xf
    s_nop 1
    v_max_u32_dpp v11, v11, v11 row_bcast:31 row_mask:0xc bank_mask:0xf
    s_nop 0
    v_readlane_b32 s42, v11, 63
    s_nop 1
    v_cmp_eq_u32 vcc, s42, v8
    v_writelane_b32 v12, s42, 0
    s_nop 0
    v_cndmask_b32 v8, v8, v9, vcc
    v_cndmask_b32 v9, v9, v10, vcc
    v_cndmask_b32 v10, v10, 0, vcc
    v_max_u32_dpp v11, v8, v8 row_shr:1 row_mask:0xf bank_mask:0xf bound_ctrl:0
    s_andn2_b32 s84, 0x7ff, s42
    s_mul_i32 s84, s84, 896
    v_max_u32_dpp v11, v11, v11 row_shr:2 row_mask:0xf bank_mask:0xf
    s_nop 1
    v_max_u32_dpp v11, v11, v11 row_shr:4 row_mask:0xf bank_mask:0xf
    s_nop 1
    v_max_u32_dpp v11, v11, v11 row_shr:8 row_mask:0xf bank_mask:0xf
    s_nop 1
    v_max_u32_dpp v11, v11, v11 row_bcast:15 row_mask:0xa bank_mask:0xf
    s_nop 1
    v_max_u32_dpp v11, v11, v11 row_bcast:31 row_mask:0xc bank_mask:0xf
    s_nop 0
    v_readlane_b32 s42, v11, 63
    s_nop 1
    v_cmp_eq_u32 vcc, s42, v8
    v_writelane_b32 v12, s42, 1
    s_nop 0
    v_cndmask_b32 v8, v8, v9, vcc
    v_cndmask_b32 v9, v9, v10, vcc
    v_cndmask_b32 v10, v10, 0, vcc
    v_max_u32_dpp v11, v8, v8 row_shr:1 row_mask:0xf bank_mask:0xf bound_ctrl:0
    s_andn2_b32 s85, 0x7ff, s42
    s_mul_i32 s85, s85, 896
    v_max_u32_dpp v11, v11, v11 row_shr:2 row_mask:0xf bank_mask:0xf
    s_nop 1
    v_max_u32_dpp v11, v11, v11 row_shr:4 row_mask:0xf bank_mask:0xf
    s_nop 1
    v_max_u32_dpp v11, v11, v11 row_shr:8 row_mask:0xf bank_mask:0xf
    s_nop 1
    v_max_u32_dpp v11, v11, v11 row_bcast:15 row_mask:0xa bank_mask:0xf
    s_nop 1
    v_max_u32_dpp v11, v11, v11 row_bcast:31 row_mask:0xc bank_mask:0xf
    s_nop 0
    v_readlane_b32 s42, v11, 63
    s_nop 1
    v_cmp_eq_u32 vcc, s42, v8
    v_writelane_b32 v12, s42, 2
    s_nop 0
    v_cndmask_b32 v8, v8, v9, vcc
    v_cndmask_b32 v9, v9, v10, vcc
    v_cndmask_b32 v10, v10, 0, vcc
    v_max_u32_dpp v11, v8, v8 row_shr:1 row_mask:0xf bank_mask:0xf bound_ctrl:0
    s_andn2_b32 s86, 0x7ff, s42
    s_mul_i32 s86, s86, 896
    v_max_u32_dpp v11, v11, v11 row_shr:2 row_mask:0xf bank_mask:0xf
    s_nop 1
    v_max_u32_dpp v11, v11, v11 row_shr:4 row_mask:0xf bank_mask:0xf
    s_nop 1
    v_max_u32_dpp v11, v11, v11 row_shr:8 row_mask:0xf bank_mask:0xf
    s_nop 1
    v_max_u32_dpp v11, v11, v11 row_bcast:15 row_mask:0xa bank_mask:0xf
    s_nop 1
    v_max_u32_dpp v11, v11, v11 row_bcast:31 row_mask:0xc bank_mask:0xf
    s_nop 0
    v_readlane_b32 s42, v11, 63
    s_nop 1
    v_cmp_eq_u32 vcc, s42, v8
    v_writelane_b32 v12, s42, 3
    s_nop 0
    v_cndmask_b32 v8, v8, v9, vcc
    v_cndmask_b32 v9, v9, v10, vcc
    v_cndmask_b32 v10, v10, 0, vcc
    v_max_u32_dpp v11, v8, v8 row_shr:1 row_mask:0xf bank_mask:0xf bound_ctrl:0
    s_andn2_b32 s87, 0x7ff, s42
    s_mul_i32 s87, s87, 896
    v_max_u32_dpp v11, v11, v11 row_shr:2 row_mask:0xf bank_mask:0xf
    s_nop 1
    v_max_u32_dpp v11, v11, v11 row_shr:4 row_mask:0xf bank_mask:0xf
    s_nop 1
    v_max_u32_dpp v11, v11, v11 row_shr:8 row_mask:0xf bank_mask:0xf
    s_nop 1
    v_max_u32_dpp v11, v11, v11 row_bcast:15 row_mask:0xa bank_mask:0xf
    s_nop 1
    v_max_u32_dpp v11, v11, v11 row_bcast:31 row_mask:0xc bank_mask:0xf
    s_nop 0
    v_readlane_b32 s42, v11, 63
    s_nop 1
    v_cmp_eq_u32 vcc, s42, v8
    v_writelane_b32 v12, s42, 4
    s_nop 0
    v_cndmask_b32 v8, v8, v9, vcc
    v_cndmask_b32 v9, v9, v10, vcc
    v_cndmask_b32 v10, v10, 0, vcc
    v_max_u32_dpp v11, v8, v8 row_shr:1 row_mask:0xf bank_mask:0xf bound_ctrl:0
    s_andn2_b32 s88, 0x7ff, s42
    s_mul_i32 s88, s88, 896
    v_max_u32_dpp v11, v11, v11 row_shr:2 row_mask:0xf bank_mask:0xf
    s_nop 1
    v_max_u32_dpp v11, v11, v11 row_shr:4 row_mask:0xf bank_mask:0xf
    s_nop 1
    v_max_u32_dpp v11, v11, v11 row_shr:8 row_mask:0xf bank_mask:0xf
    s_nop 1
    v_max_u32_dpp v11, v11, v11 row_bcast:15 row_mask:0xa bank_mask:0xf
    s_nop 1
    v_max_u32_dpp v11, v11, v11 row_bcast:31 row_mask:0xc bank_mask:0xf
    s_nop 0
    v_readlane_b32 s42, v11, 63
    s_nop 1
    v_cmp_eq_u32 vcc, s42, v8
    v_writelane_b32 v12, s42, 5
    s_nop 0
    v_cndmask_b32 v8, v8, v9, vcc
    v_cndmask_b32 v9, v9, v10, vcc
    v_cndmask_b32 v10, v10, 0, vcc
    v_max_u32_dpp v11, v8, v8 row_shr:1 row_mask:0xf bank_mask:0xf bound_ctrl:0
    s_andn2_b32 s89, 0x7ff, s42
    s_mul_i32 s89, s89, 896
    v_max_u32_dpp v11, v11, v11 row_shr:2 row_mask:0xf bank_mask:0xf
    s_nop 1
    v_max_u32_dpp v11, v11, v11 row_shr:4 row_mask:0xf bank_mask:0xf
    s_nop 1
    v_max_u32_dpp v11, v11, v11 row_shr:8 row_mask:0xf bank_mask:0xf
    s_nop 1
    v_max_u32_dpp v11, v11, v11 row_bcast:15 row_mask:0xa bank_mask:0xf
    s_nop 1
    v_max_u32_dpp v11, v11, v11 row_bcast:31 row_mask:0xc bank_mask:0xf
    s_nop 0
    v_readlane_b32 s42, v11, 63
    s_nop 1
    v_cmp_eq_u32 vcc, s42, v8
    v_writelane_b32 v12, s42, 6
    s_nop 0
    v_cndmask_b32 v8, v8, v9, vcc
    v_cndmask_b32 v9, v9, v10, vcc
    v_cndmask_b32 v10, v10, 0, vcc
    v_max_u32_dpp v11, v8, v8 row_shr:1 row_mask:0xf bank_mask:0xf bound_ctrl:0
    s_andn2_b32 s90, 0x7ff, s42
    s_mul_i32 s90, s90, 896
    v_max_u32_dpp v11, v11, v11 row_shr:2 row_mask:0xf bank_mask:0xf
    s_nop 1
    v_max_u32_dpp v11, v11, v11 row_shr:4 row_mask:0xf bank_mask:0xf
    s_nop 1
    v_max_u32_dpp v11, v11, v11 row_shr:8 row_mask:0xf bank_mask:0xf
    s_nop 1
    v_max_u32_dpp v11, v11, v11 row_bcast:15 row_mask:0xa bank_mask:0xf
    s_nop 1
    v_max_u32_dpp v11, v11, v11 row_bcast:31 row_mask:0xc bank_mask:0xf
    s_nop 0
    v_readlane_b32 s42, v11, 63
    s_nop 1
    v_cmp_eq_u32 vcc, s42, v8
    v_writelane_b32 v12, s42, 7
    s_nop 0
    v_cndmask_b32 v8, v8, v9, vcc
    v_cndmask_b32 v9, v9, v10, vcc
    v_cndmask_b32 v10, v10, 0, vcc
    v_cmp_eq_u32 vcc, 0, v8
    s_andn2_b32 s91, 0x7ff, s42
    s_mul_i32 s91, s91, 896
    s_cbranch_vccz L_f_topdone
    s_mov_b32 m0, 0
    s_mov_b32 s42, -1
L_f_slow:
    v_sub_u32 v8, s42, v64
    v_sub_u32 v9, s42, v65
    v_min_u32 v8, v8, v9
    v_sub_u32 v9, s42, v66
    v_sub_u32 v10, s42, v67
    v_min3_u32 v8, v8, v9, v10
    v_sub_u32 v9, s42, v68
    v_sub_u32 v10, s42, v69
    v_min3_u32 v8, v8, v9, v10
    v_sub_u32 v9, s42, v70
    v_sub_u32 v10, s42, v71
    v_min3_u32 v8, v8, v9, v10
    v_sub_u32 v9, s42, v72
    v_sub_u32 v10, s42, v73
    v_min3_u32 v8, v8, v9, v10
    v_sub_u32 v9, s42, v74
    v_sub_u32 v10, s42, v75
    v_min3_u32 v8, v8, v9, v10
    v_sub_u32 v9, s42, v76
    v_sub_u32 v10, s42, v77
    v_min3_u32 v8, v8, v9, v10
    v_sub_u32 v9, s42, v78
    v_sub_u32 v10, s42, v79
    v_min3_u32 v8, v8, v9, v10
    v_sub_u32 v9, s42, v80
    v_sub_u32 v10, s42, v81
    v_min3_u32 v8, v8, v9, v10
    v_sub_u32 v9, s42, v82
    v_sub_u32 v10, s42, v83
    v_min3_u32 v8, v8, v9, v10
    v_sub_u32 v9, s42, v84
    v_sub_u32 v10, s42, v85
    v_min3_u32 v8, v8, v9, v10
    v_sub_u32 v9, s42, v86
    v_sub_u32 v10, s42, v87
    v_min3_u32 v8, v8, v9, v10
    v_sub_u32 v9, s42, v88
    v_sub_u32 v10, s42, v89
    v_min3_u32 v8, v8, v9, v10
    v_sub_u32 v9, s42, v90
    v_sub_u32 v10, s42, v91
    v_min3_u32 v8, v8, v9, v10
    v_sub_u32 v9, s42, v92
    v_sub_u32 v10, s42, v93
    v_min3_u32 v8, v8, v9, v10
    v_sub_u32 v9, s42, v94
    v_sub_u32 v10, s42, v95
    v_min3_u32 v8, v8, v9, v10
    s_nop 1
    v_min_u32_dpp v8, v8, v8 row_shr:1 row_mask:0xf bank_mask:0xf
    s_nop 1
    v_min_u32_dpp v8, v8, v8 row_shr:2 row_mask:0xf bank_mask:0xf
    s_nop 1
    v_min_u32_dpp v8, v8, v8 row_shr:4 row_mask:0xf bank_mask:0xf
    s_nop 1
    v_min_u32_dpp v8, v8, v8 row_shr:8 row_mask:0xf bank_mask:0xf
    s_nop 1
    v_min_u32_dpp v8, v8, v8 row_bcast:15 row_mask:0xa bank_mask:0xf
    s_nop 1
    v_min_u32_dpp v8, v8, v8 row_bcast:31 row_mask:0xc bank_mask:0xf
    s_nop 0
    v_readlane_b32 s47, v8, 63
    s_nop 3
    s_sub_u32 s42, s42, s47
    v_writelane_b32 v12, s42, m0
    s_sub_u32 s42, s42, 1
    s_add_u32 m0, m0, 1
    s_cmp_lt_u32 m0, 8
    s_cbranch_scc1 L_f_slow
    v_readlane_b32 s84, v12, 0
    v_readlane_b32 s85, v12, 1
    v_readlane_b32 s86, v12, 2
    v_readlane_b32 s87, v12, 3
    v_readlane_b32 s88, v12, 4
    v_readlane_b32 s89, v12, 5
    v_readlane_b32 s90, v12, 6
    v_readlane_b32 s91, v12, 7
    s_nop 3
    s_andn2_b32 s84, 0x7ff, s84
    s_mul_i32 s84, s84, 896
    s_andn2_b32 s85, 0x7ff, s85
    s_mul_i32 s85, s85, 896
    s_andn2_b32 s86, 0x7ff, s86
    s_mul_i32 s86, s86, 896
    s_andn2_b32 s87, 0x7ff, s87
    s_mul_i32 s87, s87, 896
    s_andn2_b32 s88, 0x7ff, s88
    s_mul_i32 s88, s88, 896
    s_andn2_b32 s89, 0x7ff, s89
    s_mul_i32 s89, s89, 896
    s_andn2_b32 s90, 0x7ff, s90
    s_mul_i32 s90, s90, 896
    s_andn2_b32 s91, 0x7ff, s91
    s_mul_i32 s91, s91, 896
L_f_topdone:
    s_mov_b32 m0, 0
    ds_bpermute_b32 v15, v13, v12
    s_mov_b32 s47, 0
    s_waitcnt vmcnt(0)
L_f_gather:
    buffer_load_dwordx4 v6, s[48:51], s84 offen sc1 lds
    s_mov_b32 m0, 1056
    s_nop 0
    buffer_load_dwordx4 v6, s[48:51], s85 offen sc1 lds
    s_mov_b32 m0, 2112
    s_nop 0
    buffer_load_dwordx4 v6, s[48:51], s86 offen sc1 lds
    s_mov_b32 m0, 3168
    s_nop 0
    buffer_load_dwordx4 v6, s[48:51], s87 offen sc1 lds
    s_mov_b32 m0, 4224
    s_waitcnt lgkmcnt(0)
    v_not_b32 v9, v15
    v_and_b32 v9, 0x7ff, v9
    buffer_load_dwordx4 v6, s[48:51], s88 offen sc1 lds
    s_mov_b32 m0, 5280
    v_and_b32 v21, 63, v9
    v_and_b32 v22, 31, v9
    v_lshrrev_b32 v23, 10, v9
    buffer_load_dwordx4 v6, s[48:51], s89 offen sc1 lds
    s_mov_b32 m0, 6336
    v_lshl_add_u32 v22, v23, 5, v22
    v_lshrrev_b32 v23, 5, v21
    v_lshl_add_u32 v10, v23, 6, v22
    buffer_load_dwordx4 v6, s[48:51], s90 offen sc1 lds
    s_mov_b32 m0, 7392
    v_bfe_u32 v23, v9, 6, 4
    v_lshlrev_b32 v10, 7, v10
    v_lshl_add_u32 v10, v23, 2, v10
    buffer_load_dwordx4 v6, s[48:51], s91 offen sc1 lds
    buffer_load_dword v11, v10, s[24:27], s58 offen offset:64 sc1
    v_mad_u32_u24 v20, v9, s44, v14
    buffer_load_dwordx2 v[16:17], v20, s[48:51], 0 offen sc1
    v_lshlrev_b32 v22, 2, v22
    ds_bpermute_b32 v23, v22, v28
    ds_bpermute_b32 v22, v22, v29
    v_cmp_gt_u32 vcc, 32, v21
    s_add_u32 s47, s47, 1
    s_waitcnt lgkmcnt(0)
    v_cndmask_b32 v22, v22, v23, vcc
    v_cmp_eq_u32 vcc, 0, v22
    s_cbranch_vccz L_f_flagok
    buffer_load_dword v28, v19, s[24:27], s56 offen sc1
    buffer_load_dword v29, v19, s[24:27], s57 offen sc1
    s_mov_b32 m0, 0
    s_waitcnt vmcnt(0)
    s_cmp_lt_u32 s47, 0x40000
    s_cbranch_scc1 L_f_gather
L_f_flagok:
    v_lshlrev_b32 v30, 2, v1
    s_waitcnt vmcnt(1)
    s_mov_b64 exec, 0xff
    ds_write_b32 v30, v11 offset:15424
    s_mov_b64 exec, -1
    s_waitcnt lgkmcnt(0)
    s_barrier
    v_ashrrev_i32 v9, 31, v15
    v_not_b32 v9, v9
    v_or_b32 v9, 0x80000000, v9
    v_xor_b32 v15, v15, v9
    v_and_b32 v15, s45, v15
    v_mul_f32 v18, 0xbfb8aa3b, v15
    v_exp_f32 v18, v18
    v_mov_b32 v10, 1.0
    v_add_f32 v18, 1.0, v18
    v_rcp_f32 v18, v18
    s_mov_b32 s47, 0
    v_cvt_pk_bf16_f32 v18, v18, v18
    v_and_b32 v18, s45, v18
    v_mov_b32 v14, v20
    s_waitcnt vmcnt(0)
    v_lshlrev_b32 v20, 16, v16
    v_and_b32 v21, s45, v16
    v_lshlrev_b32 v22, 16, v17
    v_and_b32 v23, s45, v17
    s_barrier
    s_barrier
L_f_pp:
    buffer_load_dwordx4 v[64:67], v24, s[24:27], s52 offen sc1
    buffer_load_dwordx4 v[68:71], v25, s[24:27], s52 offen sc1
    buffer_load_dwordx4 v[72:75], v26, s[24:27], s52 offen sc1
    buffer_load_dwordx4 v[76:79], v27, s[24:27], s52 offen sc1
    buffer_load_dwordx4 v[80:83], v24, s[24:27], s53 offen sc1
    buffer_load_dwordx4 v[84:87], v25, s[24:27], s53 offen sc1
    buffer_load_dwordx4 v[88:91], v26, s[24:27], s53 offen sc1
    buffer_load_dwordx4 v[92:95], v27, s[24:27], s53 offen sc1
    buffer_load_dwordx4 v[96:99], v24, s[24:27], s54 offen sc1
    buffer_load_dwordx4 v[100:103], v25, s[24:27], s54 offen sc1
    buffer_load_dwordx4 v[104:107], v26, s[24:27], s54 offen sc1
    buffer_load_dwordx4 v[108:111], v27, s[24:27], s54 offen sc1
    buffer_load_dwordx4 v[112:115], v24, s[24:27], s55 offen sc1
    buffer_load_dwordx4 v[116:119], v25, s[24:27], s55 offen sc1
    s_add_u32 s47, s47, 1
    s_waitcnt vmcnt(12)
    v_pk_add_f32 v[28:29], v[64:65], v[68:69]
    v_pk_add_f32 v[30:31], v[66:67], v[70:71]
    s_waitcnt vmcnt(11)
    v_pk_add_f32 v[28:29], v[28:29], v[72:73]
    v_pk_add_f32 v[30:31], v[30:31], v[74:75]
    s_waitcnt vmcnt(10)
    v_pk_add_f32 v[28:29], v[28:29], v[76:77]
    v_pk_add_f32 v[30:31], v[30:31], v[78:79]
    s_waitcnt vmcnt(9)
    v_pk_add_f32 v[28:29], v[28:29], v[80:81]
    v_pk_add_f32 v[30:31], v[30:31], v[82:83]
    s_waitcnt vmcnt(8)
    v_pk_add_f32 v[28:29], v[28:29], v[84:85]
    v_pk_add_f32 v[30:31], v[30:31], v[86:87]
    s_waitcnt vmcnt(7)
    v_pk_add_f32 v[28:29], v[28:29], v[88:89]
    v_pk_add_f32 v[30:31], v[30:31], v[90:91]
    s_waitcnt vmcnt(6)
    v_pk_add_f32 v[28:29], v[28:29], v[92:93]
    v_pk_add_f32 v[30:31], v[30:31], v[94:95]
    s_waitcnt vmcnt(5)
    v_pk_add_f32 v[28:29], v[28:29], v[96:97]
    v_pk_add_f32 v[30:31], v[30:31], v[98:99]
    s_waitcnt vmcnt(4)
    v_pk_add_f32 v[28:29], v[28:29], v[100:101]
    v_pk_add_f32 v[30:31], v[30:31], v[102:103]
    s_waitcnt vmcnt(3)
    v_pk_add_f32 v[28:29], v[28:29], v[104:105]
    v_pk_add_f32 v[30:31], v[30:31], v[106:107]
    s_waitcnt vmcnt(2)
    v_pk_add_f32 v[28:29], v[28:29], v[108:109]
    v_pk_add_f32 v[30:31], v[30:31], v[110:111]
    s_waitcnt vmcnt(1)
    v_pk_add_f32 v[28:29], v[28:29], v[112:113]
    v_pk_add_f32 v[30:31], v[30:31], v[114:115]
    s_waitcnt vmcnt(0)
    v_pk_add_f32 v[28:29], v[28:29], v[116:117]
    v_pk_add_f32 v[30:31], v[30:31], v[118:119]
    v_add_f32 v8, v28, v29
    v_add_f32 v9, v30, v31
    v_cmp_u_f32 vcc, v8, v9
    s_cbranch_vccz L_f_got
    v_max3_u32 v8, v64, v65, v66
    v_max3_u32 v8, v8, v67, v68
    v_max3_u32 v8, v8, v69, v70
    v_max3_u32 v8, v8, v71, v72
    v_max3_u32 v8, v8, v73, v74
    v_max3_u32 v8, v8, v75, v76
    v_max3_u32 v8, v8, v77, v78
    v_max3_u32 v8, v8, v79, v80
    v_max3_u32 v8, v8, v81, v82
    v_max3_u32 v8, v8, v83, v84
    v_max3_u32 v8, v8, v85, v86
    v_max3_u32 v8, v8, v87, v88
    v_max3_u32 v8, v8, v89, v90
    v_max3_u32 v8, v8, v91, v92
    v_max3_u32 v8, v8, v93, v94
    v_max3_u32 v8, v8, v95, v96
    v_max3_u32 v8, v8, v97, v98
    v_max3_u32 v8, v8, v99, v100
    v_max3_u32 v8, v8, v101, v102
    v_max3_u32 v8, v8, v103, v104
    v_max3_u32 v8, v8, v105, v106
    v_max3_u32 v8, v8, v107, v108
    v_max3_u32 v8, v8, v109, v110
    v_max3_u32 v8, v8, v111, v112
    v_max3_u32 v8, v8, v113, v114
    v_max3_u32 v8, v8, v115, v116
    v_max3_u32 v8, v8, v117, v118
    v_max_u32 v8, v8, v119
    v_cmp_eq_u32 vcc, -1, v8
    s_cbranch_vccz L_f_got
    s_cmp_lt_u32 s47, 0x40000
    s_cbranch_scc1 L_f_pp
L_f_got:
    v_mov_b32 v32, v28
    v_mov_b32 v33, v29
    v_mov_b32 v34, v30
    v_mov_b32 v35, v31
    v_permlane16_swap_b32 v28, v32
    v_permlane16_swap_b32 v29, v33
    v_permlane16_swap_b32 v30, v34
    v_permlane16_swap_b32 v31, v35
    v_pk_add_f32 v[28:29], v[28:29], v[32:33]
    v_pk_add_f32 v[30:31], v[30:31], v[34:35]
    v_mov_b32 v32, v28
    v_mov_b32 v33, v29
    v_mov_b32 v34, v30
    v_mov_b32 v35, v31
    v_permlane32_swap_b32 v28, v32
    v_permlane32_swap_b32 v29, v33
    v_permlane32_swap_b32 v30, v34
    v_permlane32_swap_b32 v31, v35
    v_pk_add_f32 v[28:29], v[28:29], v[32:33]
    v_pk_add_f32 v[30:31], v[30:31], v[34:35]
    v_fma_f32 v24, v28, v18, v20
    v_fma_f32 v25, v29, v18, v21
    v_fma_f32 v26, v30, v18, v22
    v_fma_f32 v27, v31, v18, v23
    v_cvt_pk_bf16_f32 v16, v24, v25
    v_cvt_pk_bf16_f32 v17, v26, v27
    s_mov_b64 exec, 0xffff
    buffer_store_dwordx2 v[16:17], v14, s[48:51], 0 offen sc1
    s_endpgm
L_kb_warm:
    s_load_dwordx4 s[4:7], s[0:1], 56
    s_load_dwordx2 s[8:9], s[0:1], 72
    s_sub_u32 s19, s2, 184
    s_and_b32 s19, s19, 0xf8
    s_add_u32 s19, s19, s43
    s_add_u32 s19, s19, 41
    s_waitcnt lgkmcnt(0)
    s_and_b32 s30, s2, 7
    s_cmp_ge_u32 s19, 56
    s_cbranch_scc1 L_xt_dc
    s_cmp_ge_u32 s19, 28
    s_cselect_b32 s31, 28, 0
    s_cselect_b32 s24, s6, s4
    s_cselect_b32 s25, s7, s5
    s_sub_u32 s29, s19, s31
    s_mul_i32 s29, s29, 57344
    s_mul_i32 s30, s30, 448
    s_and_b32 s30, s30, 0xffffff80
    s_add_u32 s29, s29, s30
    v_lshrrev_b32 v8, 2, v1
    v_mul_u32_u24 v8, 3584, v8
    v_and_b32 v9, 3, v1
    v_lshl_add_u32 v8, v9, 7, v8
    s_branch L_xt_goc
L_xt_dc:
    s_mov_b32 s24, s8
    s_mov_b32 s25, s9
    s_sub_u32 s29, s19, 56
    s_lshl_b32 s29, s29, 13
    s_mul_i32 s30, s30, 200704
    s_add_u32 s29, s29, s30
    s_cmp_ge_u32 s19, 81
    s_cselect_b32 s29, 0x7ff00000, s29
    v_lshlrev_b32 v8, 7, v1
L_xt_goc:
    v_add_u32 v8, s29, v8
    s_mov_b32 s26, 0x188000
    s_mov_b32 s27, 0x20000
    buffer_load_dword v11, v8, s[24:27], 0 offen
    s_endpgm
L_kb_end:
    s_endpgm
.p2align 7
.type fnet_tables,@object
fnet_tables:
.long 0x3f803f80, 0x3f803f80, 0x3f803f80, 0x3f803f80, 0x3f7f3f80, 0x3f753f7b, 0x3f623f6d, 0x3f463f55
.long 0x3f7b3f80, 0x3f553f6d, 0x3f0e3f35, 0x3e483ec4, 0x3f753f80, 0x3f223f55, 0x3dc93ec4, 0xbef1be48
.long 0x3f6d3f80, 0x3ec43f35, 0xbec40000, 0xbf6dbf35, 0x3f623f80, 0x3dc93f0e, 0xbf46bec4, 0xbf75bf7b
.long 0x3f553f80, 0xbe483ec4, 0xbf7bbf35, 0xbf0ebf6d, 0x3f463f80, 0xbef13e48, 0xbf75bf6d, 0x3dc9bf0e
.long 0x3f353f80, 0xbf350000, 0xbf35bf80, 0x3f358000, 0x3f223f80, 0xbf62be48, 0xbe95bf6d, 0x3f7f3f0e
.long 0x3f0e3f80, 0xbf7bbec4, 0x3e48bf35, 0x3f553f6d, 0x3ef13f80, 0xbf7fbf0e, 0x3f22bec4, 0x3e953f7b
.long 0x3ec43f80, 0xbf6dbf35, 0x3f6d8000, 0xbec43f35, 0x3e953f80, 0xbf46bf55, 0x3f7f3ec4, 0xbf623e48
.long 0x3e483f80, 0xbf0ebf6d, 0x3f553f35, 0xbf7bbec4, 0x3dc93f80, 0xbe95bf7b, 0x3ef13f6d, 0xbf22bf55
.long 0x3f803f80, 0x3f803f80, 0x3f803f80, 0x3f803f80, 0x3f223f35, 0x3ef13f0e, 0x3e953ec4, 0x3dc93e48
.long 0xbe480000, 0xbf0ebec4, 0xbf55bf35, 0xbf7bbf6d, 0xbf62bf35, 0xbf7fbf7b, 0xbf46bf6d, 0xbe95bf0e
.long 0xbf6dbf80, 0xbec4bf35, 0x3ec48000, 0x3f6d3f35, 0xbe95bf35, 0x3f223e48, 0x3f7f3f6d, 0x3ef13f55
.long 0x3f0e8000, 0x3f7b3f6d, 0x3e483f35, 0xbf55bec4, 0x3f7f3f35, 0x3e953f55, 0xbf62bec4, 0xbf22bf7b
.long 0x3f353f80, 0xbf350000, 0xbf35bf80, 0x3f358000, 0xbdc93f35, 0xbf75bf55, 0x3ef1bec4, 0x3f463f7b
.long 0xbf550000, 0xbe48bf6d, 0x3f7b3f35, 0xbf0e3ec4, 0xbf75bf35, 0x3f46be48, 0x3dc93f6d, 0xbf62bf55
.long 0xbec4bf80, 0x3f6d3f35, 0xbf6d0000, 0x3ec4bf35, 0x3ef1bf35, 0x3dc93f7b, 0xbf22bf6d, 0x3f753f0e
.long 0x3f7b8000, 0xbf553ec4, 0x3f0ebf35, 0xbe483f6d, 0x3f463f35, 0xbf62bf0e, 0x3f753ec4, 0xbf7fbe48
.long 0x3f803f80, 0x3f803f80, 0x3f803f80, 0x3f803f80, 0xbdc90000, 0xbe95be48, 0xbef1bec4, 0xbf22bf0e
.long 0xbf7bbf80, 0xbf55bf6d, 0xbf0ebf35, 0xbe48bec4, 0x3e958000, 0x3f463f0e, 0x3f7f3f6d, 0x3f623f7b
.long 0x3f6d3f80, 0x3ec43f35, 0xbec40000, 0xbf6dbf35, 0xbef10000, 0xbf7fbf55, 0xbf22bf6d, 0x3e95be48
.long 0xbf55bf80, 0x3e48bec4, 0x3f7b3f35, 0x3f0e3f6d, 0x3f228000, 0x3f623f7b, 0xbe953ec4, 0xbf7fbf55
.long 0x3f353f80, 0xbf350000, 0xbf35bf80, 0x3f358000, 0xbf460000, 0xbef1bf7b, 0x3f753ec4, 0x3dc93f55
.long 0xbf0ebf80, 0x3f7b3ec4, 0xbe483f35, 0xbf55bf6d, 0x3f628000, 0xbdc93f55, 0xbf46bf6d, 0x3f753e48
.long 0x3ec43f80, 0xbf6dbf35, 0x3f6d8000, 0xbec43f35, 0xbf750000, 0x3f22bf0e, 0xbdc93f6d, 0xbef1bf7b
.long 0xbe48bf80, 0x3f0e3f6d, 0xbf55bf35, 0x3f7b3ec4, 0x3f7f8000, 0xbf753e48, 0x3f62bec4, 0xbf463f0e
.long 0x3f803f80, 0x3f803f80, 0x3f803f80, 0x3f803f80, 0xbf46bf35, 0xbf62bf55, 0xbf75bf6d, 0xbf7fbf7b
.long 0x3e488000, 0x3f0e3ec4, 0x3f553f35, 0x3f7b3f6d, 0x3ef13f35, 0xbdc93e48, 0xbf22bec4, 0xbf75bf55
.long 0xbf6dbf80, 0xbec4bf35, 0x3ec48000, 0x3f6d3f35, 0x3f753f35, 0x3f463f7b, 0xbdc93ec4, 0xbf62bf0e
.long 0xbf0e0000, 0xbf7bbf6d, 0xbe48bf35, 0x3f553ec4, 0xbdc9bf35, 0x3f753f0e, 0x3ef13f6d, 0xbf46be48
.long 0x3f353f80, 0xbf350000, 0xbf35bf80, 0x3f358000, 0xbf7fbf35, 0x3e95bf0e, 0x3f623f6d, 0xbf223e48
.long 0x3f558000, 0x3e483f6d, 0xbf7bbf35, 0x3f0ebec4, 0xbe953f35, 0xbf22bf7b, 0x3f7f3ec4, 0xbef13f0e
.long 0xbec4bf80, 0x3f6d3f35, 0xbf6d0000, 0x3ec4bf35, 0x3f623f35, 0xbf7fbe48, 0x3f46bec4, 0xbe953f55
.long 0xbf7b0000, 0x3f55bec4, 0xbf0e3f35, 0x3e48bf6d, 0x3f22bf35, 0xbef13f55, 0x3e95bf6d, 0xbdc93f7b
.long 0x3f803f80, 0x3f803f80, 0x3f803f80, 0x3f803f80, 0xbf7fbf80, 0xbf75bf7b, 0xbf62bf6d, 0xbf46bf55
.long 0x3f7b3f80, 0x3f553f6d, 0x3f0e3f35, 0x3e483ec4, 0xbf75bf80, 0xbf22bf55, 0xbdc9bec4, 0x3ef13e48
.long 0x3f6d3f80, 0x3ec43f35, 0xbec40000, 0xbf6dbf35, 0xbf62bf80, 0xbdc9bf0e, 0x3f463ec4, 0x3f753f7b
.long 0x3f553f80, 0xbe483ec4, 0xbf7bbf35, 0xbf0ebf6d, 0xbf46bf80, 0x3ef1be48, 0x3f753f6d, 0xbdc93f0e
.long 0x3f353f80, 0xbf350000, 0xbf35bf80, 0x3f358000, 0xbf22bf80, 0x3f623e48, 0x3e953f6d, 0xbf7fbf0e
.long 0x3f0e3f80, 0xbf7bbec4, 0x3e48bf35, 0x3f553f6d, 0xbef1bf80, 0x3f7f3f0e, 0xbf223ec4, 0xbe95bf7b
.long 0x3ec43f80, 0xbf6dbf35, 0x3f6d8000, 0xbec43f35, 0xbe95bf80, 0x3f463f55, 0xbf7fbec4, 0x3f62be48
.long 0x3e483f80, 0xbf0ebf6d, 0x3f553f35, 0xbf7bbec4, 0xbdc9bf80, 0x3e953f7b, 0xbef1bf6d, 0x3f223f55
.long 0x3f803f80, 0x3f803f80, 0x3f803f80, 0x3f803f80, 0xbf22bf35, 0xbef1bf0e, 0xbe95bec4, 0xbdc9be48
.long 0xbe480000, 0xbf0ebec4, 0xbf55bf35, 0xbf7bbf6d, 0x3f623f35, 0x3f7f3f7b, 0x3f463f6d, 0x3e953f0e
.long 0xbf6dbf80, 0xbec4bf35, 0x3ec48000, 0x3f6d3f35, 0x3e953f35, 0xbf22be48, 0xbf7fbf6d, 0xbef1bf55
.long 0x3f0e8000, 0x3f7b3f6d, 0x3e483f35, 0xbf55bec4, 0xbf7fbf35, 0xbe95bf55, 0x3f623ec4, 0x3f223f7b
.long 0x3f353f80, 0xbf350000, 0xbf35bf80, 0x3f358000, 0x3dc9bf35, 0x3f753f55, 0xbef13ec4, 0xbf46bf7b
.long 0xbf550000, 0xbe48bf6d, 0x3f7b3f35, 0xbf0e3ec4, 0x3f753f35, 0xbf463e48, 0xbdc9bf6d, 0x3f623f55
.long 0xbec4bf80, 0x3f6d3f35, 0xbf6d0000, 0x3ec4bf35, 0xbef13f35, 0xbdc9bf7b, 0x3f223f6d, 0xbf75bf0e
.long 0x3f7b8000, 0xbf553ec4, 0x3f0ebf35, 0xbe483f6d, 0xbf46bf35, 0x3f623f0e, 0xbf75bec4, 0x3f7f3e48
.long 0x3f803f80, 0x3f803f80, 0x3f803f80, 0x3f803f80, 0x3dc98000, 0x3e953e48, 0x3ef13ec4, 0x3f223f0e
.long 0xbf7bbf80, 0xbf55bf6d, 0xbf0ebf35, 0xbe48bec4, 0xbe950000, 0xbf46bf0e, 0xbf7fbf6d, 0xbf62bf7b
.long 0x3f6d3f80, 0x3ec43f35, 0xbec40000, 0xbf6dbf35, 0x3ef18000, 0x3f7f3f55, 0x3f223f6d, 0xbe953e48
.long 0xbf55bf80, 0x3e48bec4, 0x3f7b3f35, 0x3f0e3f6d, 0xbf220000, 0xbf62bf7b, 0x3e95bec4, 0x3f7f3f55
.long 0x3f353f80, 0xbf350000, 0xbf35bf80, 0x3f358000, 0x3f468000, 0x3ef13f7b, 0xbf75bec4, 0xbdc9bf55
.long 0xbf0ebf80, 0x3f7b3ec4, 0xbe483f35, 0xbf55bf6d, 0xbf620000, 0x3dc9bf55, 0x3f463f6d, 0xbf75be48
.long 0x3ec43f80, 0xbf6dbf35, 0x3f6d8000, 0xbec43f35, 0x3f758000, 0xbf223f0e, 0x3dc9bf6d, 0x3ef13f7b
.long 0xbe48bf80, 0x3f0e3f6d, 0xbf55bf35, 0x3f7b3ec4, 0xbf7f0000, 0x3f75be48, 0xbf623ec4, 0x3f46bf0e
.long 0x3f803f80, 0x3f803f80, 0x3f803f80, 0x3f803f80, 0x3f463f35, 0x3f623f55, 0x3f753f6d, 0x3f7f3f7b
.long 0x3e488000, 0x3f0e3ec4, 0x3f553f35, 0x3f7b3f6d, 0xbef1bf35, 0x3dc9be48, 0x3f223ec4, 0x3f753f55
.long 0xbf6dbf80, 0xbec4bf35, 0x3ec48000, 0x3f6d3f35, 0xbf75bf35, 0xbf46bf7b, 0x3dc9bec4, 0x3f623f0e
.long 0xbf0e0000, 0xbf7bbf6d, 0xbe48bf35, 0x3f553ec4, 0x3dc93f35, 0xbf75bf0e, 0xbef1bf6d, 0x3f463e48
.long 0x3f353f80, 0xbf350000, 0xbf35bf80, 0x3f358000, 0x3f7f3f35, 0xbe953f0e, 0xbf62bf6d, 0x3f22be48
.long 0x3f558000, 0x3e483f6d, 0xbf7bbf35, 0x3f0ebec4, 0x3e95bf35, 0x3f223f7b, 0xbf7fbec4, 0x3ef1bf0e
.long 0xbec4bf80, 0x3f6d3f35, 0xbf6d0000, 0x3ec4bf35, 0xbf62bf35, 0x3f7f3e48, 0xbf463ec4, 0x3e95bf55
.long 0xbf7b0000, 0x3f55bec4, 0xbf0e3f35, 0x3e48bf6d, 0xbf223f35, 0x3ef1bf55, 0xbe953f6d, 0x3dc9bf7b
.long 0x00003f80, 0x8000bf80, 0x00003f80, 0x8000bf80, 0xbdc93f80, 0x3e95bf7b, 0xbef13f6d, 0x3f22bf55
.long 0xbe483f80, 0x3f0ebf6d, 0xbf553f35, 0x3f7bbec4, 0xbe953f80, 0x3f46bf55, 0xbf7f3ec4, 0x3f623e48
.long 0xbec43f80, 0x3f6dbf35, 0xbf6d0000, 0x3ec43f35, 0xbef13f80, 0x3f7fbf0e, 0xbf22bec4, 0xbe953f7b
.long 0xbf0e3f80, 0x3f7bbec4, 0xbe48bf35, 0xbf553f6d, 0xbf223f80, 0x3f62be48, 0x3e95bf6d, 0xbf7f3f0e
.long 0xbf353f80, 0x3f358000, 0x3f35bf80, 0xbf350000, 0xbf463f80, 0x3ef13e48, 0x3f75bf6d, 0xbdc9bf0e
.long 0xbf553f80, 0x3e483ec4, 0x3f7bbf35, 0x3f0ebf6d, 0xbf623f80, 0xbdc93f0e, 0x3f46bec4, 0x3f75bf7b
.long 0xbf6d3f80, 0xbec43f35, 0x3ec48000, 0x3f6dbf35, 0xbf753f80, 0xbf223f55, 0xbdc93ec4, 0x3ef1be48
.long 0xbf7b3f80, 0xbf553f6d, 0xbf0e3f35, 0xbe483ec4, 0xbf7f3f80, 0xbf753f7b, 0xbf623f6d, 0xbf463f55
.long 0x00003f80, 0x8000bf80, 0x00003f80, 0x8000bf80, 0xbf463f35, 0x3f62bf0e, 0xbf753ec4, 0x3f7fbe48
.long 0xbf7b0000, 0x3f553ec4, 0xbf0ebf35, 0x3e483f6d, 0xbef1bf35, 0xbdc93f7b, 0x3f22bf6d, 0xbf753f0e
.long 0x3ec4bf80, 0xbf6d3f35, 0x3f6d8000, 0xbec4bf35, 0x3f75bf35, 0xbf46be48, 0xbdc93f6d, 0x3f62bf55
.long 0x3f558000, 0x3e48bf6d, 0xbf7b3f35, 0x3f0e3ec4, 0x3dc93f35, 0x3f75bf55, 0xbef1bec4, 0xbf463f7b
.long 0xbf353f80, 0x3f358000, 0x3f35bf80, 0xbf350000, 0xbf7f3f35, 0xbe953f55, 0x3f62bec4, 0x3f22bf7b
.long 0xbf0e0000, 0xbf7b3f6d, 0xbe483f35, 0x3f55bec4, 0x3e95bf35, 0xbf223e48, 0xbf7f3f6d, 0xbef13f55
.long 0x3f6dbf80, 0x3ec4bf35, 0xbec40000, 0xbf6d3f35, 0x3f62bf35, 0x3f7fbf7b, 0x3f46bf6d, 0x3e95bf0e
.long 0x3e488000, 0x3f0ebec4, 0x3f55bf35, 0x3f7bbf6d, 0xbf223f35, 0xbef13f0e, 0xbe953ec4, 0xbdc93e48
.long 0x00003f80, 0x8000bf80, 0x00003f80, 0x8000bf80, 0xbf7f0000, 0x3f753e48, 0xbf62bec4, 0x3f463f0e
.long 0x3e48bf80, 0xbf0e3f6d, 0x3f55bf35, 0xbf7b3ec4, 0x3f758000, 0xbf22bf0e, 0x3dc93f6d, 0x3ef1bf7b
.long 0xbec43f80, 0x3f6dbf35, 0xbf6d0000, 0x3ec43f35, 0xbf620000, 0x3dc93f55, 0x3f46bf6d, 0xbf753e48
.long 0x3f0ebf80, 0xbf7b3ec4, 0x3e483f35, 0x3f55bf6d, 0x3f468000, 0x3ef1bf7b, 0xbf753ec4, 0xbdc93f55
.long 0xbf353f80, 0x3f358000, 0x3f35bf80, 0xbf350000, 0xbf220000, 0xbf623f7b, 0x3e953ec4, 0x3f7fbf55
.long 0x3f55bf80, 0xbe48bec4, 0xbf7b3f35, 0xbf0e3f6d, 0x3ef18000, 0x3f7fbf55, 0x3f22bf6d, 0xbe95be48
.long 0xbf6d3f80, 0xbec43f35, 0x3ec48000, 0x3f6dbf35, 0xbe950000, 0xbf463f0e, 0xbf7f3f6d, 0xbf623f7b
.long 0x3f7bbf80, 0x3f55bf6d, 0x3f0ebf35, 0x3e48bec4, 0x3dc98000, 0x3e95be48, 0x3ef1bec4, 0x3f22bf0e
.long 0x00003f80, 0x8000bf80, 0x00003f80, 0x8000bf80, 0xbf22bf35, 0x3ef13f55, 0xbe95bf6d, 0x3dc93f7b
.long 0x3f7b8000, 0xbf55bec4, 0x3f0e3f35, 0xbe48bf6d, 0xbf623f35, 0x3f7fbe48, 0xbf46bec4, 0x3e953f55
.long 0x3ec4bf80, 0xbf6d3f35, 0x3f6d8000, 0xbec4bf35, 0x3e953f35, 0x3f22bf7b, 0xbf7f3ec4, 0x3ef13f0e
.long 0xbf550000, 0xbe483f6d, 0x3f7bbf35, 0xbf0ebec4, 0x3f7fbf35, 0xbe95bf0e, 0xbf623f6d, 0x3f223e48
.long 0xbf353f80, 0x3f358000, 0x3f35bf80, 0xbf350000, 0x3dc9bf35, 0xbf753f0e, 0xbef13f6d, 0x3f46be48
.long 0x3f0e8000, 0x3f7bbf6d, 0x3e48bf35, 0xbf553ec4, 0xbf753f35, 0xbf463f7b, 0x3dc93ec4, 0x3f62bf0e
.long 0x3f6dbf80, 0x3ec4bf35, 0xbec40000, 0xbf6d3f35, 0xbef13f35, 0x3dc93e48, 0x3f22bec4, 0x3f75bf55
.long 0xbe480000, 0xbf0e3ec4, 0xbf553f35, 0xbf7b3f6d, 0x3f46bf35, 0x3f62bf55, 0x3f75bf6d, 0x3f7fbf7b
.long 0x00003f80, 0x8000bf80, 0x00003f80, 0x8000bf80, 0x3dc9bf80, 0xbe953f7b, 0x3ef1bf6d, 0xbf223f55
.long 0xbe483f80, 0x3f0ebf6d, 0xbf553f35, 0x3f7bbec4, 0x3e95bf80, 0xbf463f55, 0x3f7fbec4, 0xbf62be48
.long 0xbec43f80, 0x3f6dbf35, 0xbf6d0000, 0x3ec43f35, 0x3ef1bf80, 0xbf7f3f0e, 0x3f223ec4, 0x3e95bf7b
.long 0xbf0e3f80, 0x3f7bbec4, 0xbe48bf35, 0xbf553f6d, 0x3f22bf80, 0xbf623e48, 0xbe953f6d, 0x3f7fbf0e
.long 0xbf353f80, 0x3f358000, 0x3f35bf80, 0xbf350000, 0x3f46bf80, 0xbef1be48, 0xbf753f6d, 0x3dc93f0e
.long 0xbf553f80, 0x3e483ec4, 0x3f7bbf35, 0x3f0ebf6d, 0x3f62bf80, 0x3dc9bf0e, 0xbf463ec4, 0xbf753f7b
.long 0xbf6d3f80, 0xbec43f35, 0x3ec48000, 0x3f6dbf35, 0x3f75bf80, 0x3f22bf55, 0x3dc9bec4, 0xbef13e48
.long 0xbf7b3f80, 0xbf553f6d, 0xbf0e3f35, 0xbe483ec4, 0x3f7fbf80, 0x3f75bf7b, 0x3f62bf6d, 0x3f46bf55
.long 0x00003f80, 0x8000bf80, 0x00003f80, 0x8000bf80, 0x3f46bf35, 0xbf623f0e, 0x3f75bec4, 0xbf7f3e48
.long 0xbf7b0000, 0x3f553ec4, 0xbf0ebf35, 0x3e483f6d, 0x3ef13f35, 0x3dc9bf7b, 0xbf223f6d, 0x3f75bf0e
.long 0x3ec4bf80, 0xbf6d3f35, 0x3f6d8000, 0xbec4bf35, 0xbf753f35, 0x3f463e48, 0x3dc9bf6d, 0xbf623f55
.long 0x3f558000, 0x3e48bf6d, 0xbf7b3f35, 0x3f0e3ec4, 0xbdc9bf35, 0xbf753f55, 0x3ef13ec4, 0x3f46bf7b
.long 0xbf353f80, 0x3f358000, 0x3f35bf80, 0xbf350000, 0x3f7fbf35, 0x3e95bf55, 0xbf623ec4, 0xbf223f7b
.long 0xbf0e0000, 0xbf7b3f6d, 0xbe483f35, 0x3f55bec4, 0xbe953f35, 0x3f22be48, 0x3f7fbf6d, 0x3ef1bf55
.long 0x3f6dbf80, 0x3ec4bf35, 0xbec40000, 0xbf6d3f35, 0xbf623f35, 0xbf7f3f7b, 0xbf463f6d, 0xbe953f0e
.long 0x3e488000, 0x3f0ebec4, 0x3f55bf35, 0x3f7bbf6d, 0x3f22bf35, 0x3ef1bf0e, 0x3e95bec4, 0x3dc9be48
.long 0x00003f80, 0x8000bf80, 0x00003f80, 0x8000bf80, 0x3f7f8000, 0xbf75be48, 0x3f623ec4, 0xbf46bf0e
.long 0x3e48bf80, 0xbf0e3f6d, 0x3f55bf35, 0xbf7b3ec4, 0xbf750000, 0x3f223f0e, 0xbdc9bf6d, 0xbef13f7b
.long 0xbec43f80, 0x3f6dbf35, 0xbf6d0000, 0x3ec43f35, 0x3f628000, 0xbdc9bf55, 0xbf463f6d, 0x3f75be48
.long 0x3f0ebf80, 0xbf7b3ec4, 0x3e483f35, 0x3f55bf6d, 0xbf460000, 0xbef13f7b, 0x3f75bec4, 0x3dc9bf55
.long 0xbf353f80, 0x3f358000, 0x3f35bf80, 0xbf350000, 0x3f228000, 0x3f62bf7b, 0xbe95bec4, 0xbf7f3f55
.long 0x3f55bf80, 0xbe48bec4, 0xbf7b3f35, 0xbf0e3f6d, 0xbef10000, 0xbf7f3f55, 0xbf223f6d, 0x3e953e48
.long 0xbf6d3f80, 0xbec43f35, 0x3ec48000, 0x3f6dbf35, 0x3e958000, 0x3f46bf0e, 0x3f7fbf6d, 0x3f62bf7b
.long 0x3f7bbf80, 0x3f55bf6d, 0x3f0ebf35, 0x3e48bec4, 0xbdc90000, 0xbe953e48, 0xbef13ec4, 0xbf223f0e
.long 0x00003f80, 0x8000bf80, 0x00003f80, 0x8000bf80, 0x3f223f35, 0xbef1bf55, 0x3e953f6d, 0xbdc9bf7b
.long 0x3f7b8000, 0xbf55bec4, 0x3f0e3f35, 0xbe48bf6d, 0x3f62bf35, 0xbf7f3e48, 0x3f463ec4, 0xbe95bf55
.long 0x3ec4bf80, 0xbf6d3f35, 0x3f6d8000, 0xbec4bf35, 0xbe95bf35, 0xbf223f7b, 0x3f7fbec4, 0xbef1bf0e
.long 0xbf550000, 0xbe483f6d, 0x3f7bbf35, 0xbf0ebec4, 0xbf7f3f35, 0x3e953f0e, 0x3f62bf6d, 0xbf22be48
.long 0xbf353f80, 0x3f358000, 0x3f35bf80, 0xbf350000, 0xbdc93f35, 0x3f75bf0e, 0x3ef1bf6d, 0xbf463e48
.long 0x3f0e8000, 0x3f7bbf6d, 0x3e48bf35, 0xbf553ec4, 0x3f75bf35, 0x3f46bf7b, 0xbdc9bec4, 0xbf623f0e
.long 0x3f6dbf80, 0x3ec4bf35, 0xbec40000, 0xbf6d3f35, 0x3ef1bf35, 0xbdc9be48, 0xbf223ec4, 0xbf753f55
.long 0xbe480000, 0xbf0e3ec4, 0xbf553f35, 0xbf7b3f6d, 0xbf463f35, 0xbf623f55, 0xbf753f6d, 0xbf7f3f7b
.long 0xbf803f80, 0xbf803f80, 0xbf803f80, 0xbf803f80, 0xbdc90000, 0xbe95be48, 0xbef1bec4, 0xbf22bf0e
.long 0xbe480000, 0xbf0ebec4, 0xbf55bf35, 0xbf7bbf6d, 0xbe950000, 0xbf46bf0e, 0xbf7fbf6d, 0xbf62bf7b
.long 0xbec40000, 0xbf6dbf35, 0xbf6dbf80, 0xbec4bf35, 0xbef10000, 0xbf7fbf55, 0xbf22bf6d, 0x3e95be48
.long 0xbf0e0000, 0xbf7bbf6d, 0xbe48bf35, 0x3f553ec4, 0xbf220000, 0xbf62bf7b, 0x3e95bec4, 0x3f7f3f55
.long 0xbf350000, 0xbf35bf80, 0x3f358000, 0x3f353f80, 0xbf460000, 0xbef1bf7b, 0x3f753ec4, 0x3dc93f55
.long 0xbf550000, 0xbe48bf6d, 0x3f7b3f35, 0xbf0e3ec4, 0xbf620000, 0x3dc9bf55, 0x3f463f6d, 0xbf75be48
.long 0xbf6d0000, 0x3ec4bf35, 0x3ec43f80, 0xbf6dbf35, 0xbf750000, 0x3f22bf0e, 0xbdc93f6d, 0xbef1bf7b
.long 0xbf7b0000, 0x3f55bec4, 0xbf0e3f35, 0x3e48bf6d, 0xbf7f0000, 0x3f75be48, 0xbf623ec4, 0x3f46bf0e
.long 0xbf803f80, 0xbf803f80, 0xbf803f80, 0xbf803f80, 0xbf46bf35, 0xbf62bf55, 0xbf75bf6d, 0xbf7fbf7b
.long 0xbf7bbf80, 0xbf55bf6d, 0xbf0ebf35, 0xbe48bec4, 0xbef1bf35, 0x3dc9be48, 0x3f223ec4, 0x3f753f55
.long 0x3ec48000, 0x3f6d3f35, 0x3f6d3f80, 0x3ec43f35, 0x3f753f35, 0x3f463f7b, 0xbdc93ec4, 0xbf62bf0e
.long 0x3f553f80, 0xbe483ec4, 0xbf7bbf35, 0xbf0ebf6d, 0x3dc93f35, 0xbf75bf0e, 0xbef1bf6d, 0x3f463e48
.long 0xbf350000, 0xbf35bf80, 0x3f358000, 0x3f353f80, 0xbf7fbf35, 0x3e95bf0e, 0x3f623f6d, 0xbf223e48
.long 0xbf0ebf80, 0x3f7b3ec4, 0xbe483f35, 0xbf55bf6d, 0x3e95bf35, 0x3f223f7b, 0xbf7fbec4, 0x3ef1bf0e
.long 0x3f6d8000, 0xbec43f35, 0xbec4bf80, 0x3f6d3f35, 0x3f623f35, 0xbf7fbe48, 0x3f46bec4, 0xbe953f55
.long 0x3e483f80, 0xbf0ebf6d, 0x3f553f35, 0xbf7bbec4, 0xbf223f35, 0x3ef1bf55, 0xbe953f6d, 0x3dc9bf7b
.long 0xbf803f80, 0xbf803f80, 0xbf803f80, 0xbf803f80, 0xbf7fbf80, 0xbf75bf7b, 0xbf62bf6d, 0xbf46bf55
.long 0x3e488000, 0x3f0e3ec4, 0x3f553f35, 0x3f7b3f6d, 0x3f753f80, 0x3f223f55, 0x3dc93ec4, 0xbef1be48
.long 0xbec40000, 0xbf6dbf35, 0xbf6dbf80, 0xbec4bf35, 0xbf62bf80, 0xbdc9bf0e, 0x3f463ec4, 0x3f753f7b
.long 0x3f0e8000, 0x3f7b3f6d, 0x3e483f35, 0xbf55bec4, 0x3f463f80, 0xbef13e48, 0xbf75bf6d, 0x3dc9bf0e
.long 0xbf350000, 0xbf35bf80, 0x3f358000, 0x3f353f80, 0xbf22bf80, 0x3f623e48, 0x3e953f6d, 0xbf7fbf0e
.long 0x3f558000, 0x3e483f6d, 0xbf7bbf35, 0x3f0ebec4, 0x3ef13f80, 0xbf7fbf0e, 0x3f22bec4, 0x3e953f7b
.long 0xbf6d0000, 0x3ec4bf35, 0x3ec43f80, 0xbf6dbf35, 0xbe95bf80, 0x3f463f55, 0xbf7fbec4, 0x3f62be48
.long 0x3f7b8000, 0xbf553ec4, 0x3f0ebf35, 0xbe483f6d, 0x3dc93f80, 0xbe95bf7b, 0x3ef13f6d, 0xbf22bf55
.long 0xbf803f80, 0xbf803f80, 0xbf803f80, 0xbf803f80, 0xbf22bf35, 0xbef1bf0e, 0xbe95bec4, 0xbdc9be48
.long 0x3f7b3f80, 0x3f553f6d, 0x3f0e3f35, 0x3e483ec4, 0xbf62bf35, 0xbf7fbf7b, 0xbf46bf6d, 0xbe95bf0e
.long 0x3ec48000, 0x3f6d3f35, 0x3f6d3f80, 0x3ec43f35, 0x3e953f35, 0xbf22be48, 0xbf7fbf6d, 0xbef1bf55
.long 0xbf55bf80, 0x3e48bec4, 0x3f7b3f35, 0x3f0e3f6d, 0x3f7f3f35, 0x3e953f55, 0xbf62bec4, 0xbf22bf7b
.long 0xbf350000, 0xbf35bf80, 0x3f358000, 0x3f353f80, 0x3dc9bf35, 0x3f753f55, 0xbef13ec4, 0xbf46bf7b
.long 0x3f0e3f80, 0xbf7bbec4, 0x3e48bf35, 0x3f553f6d, 0xbf75bf35, 0x3f46be48, 0x3dc93f6d, 0xbf62bf55
.long 0x3f6d8000, 0xbec43f35, 0xbec4bf80, 0x3f6d3f35, 0xbef13f35, 0xbdc9bf7b, 0x3f223f6d, 0xbf75bf0e
.long 0xbe48bf80, 0x3f0e3f6d, 0xbf55bf35, 0x3f7b3ec4, 0x3f463f35, 0xbf62bf0e, 0x3f753ec4, 0xbf7fbe48
.long 0xbf803f80, 0xbf803f80, 0xbf803f80, 0xbf803f80, 0x3dc98000, 0x3e953e48, 0x3ef13ec4, 0x3f223f0e
.long 0xbe480000, 0xbf0ebec4, 0xbf55bf35, 0xbf7bbf6d, 0x3e958000, 0x3f463f0e, 0x3f7f3f6d, 0x3f623f7b
.long 0xbec40000, 0xbf6dbf35, 0xbf6dbf80, 0xbec4bf35, 0x3ef18000, 0x3f7f3f55, 0x3f223f6d, 0xbe953e48
.long 0xbf0e0000, 0xbf7bbf6d, 0xbe48bf35, 0x3f553ec4, 0x3f228000, 0x3f623f7b, 0xbe953ec4, 0xbf7fbf55
.long 0xbf350000, 0xbf35bf80, 0x3f358000, 0x3f353f80, 0x3f468000, 0x3ef13f7b, 0xbf75bec4, 0xbdc9bf55
.long 0xbf550000, 0xbe48bf6d, 0x3f7b3f35, 0xbf0e3ec4, 0x3f628000, 0xbdc93f55, 0xbf46bf6d, 0x3f753e48
.long 0xbf6d0000, 0x3ec4bf35, 0x3ec43f80, 0xbf6dbf35, 0x3f758000, 0xbf223f0e, 0x3dc9bf6d, 0x3ef13f7b
.long 0xbf7b0000, 0x3f55bec4, 0xbf0e3f35, 0x3e48bf6d, 0x3f7f8000, 0xbf753e48, 0x3f62bec4, 0xbf463f0e
.long 0xbf803f80, 0xbf803f80, 0xbf803f80, 0xbf803f80, 0x3f463f35, 0x3f623f55, 0x3f753f6d, 0x3f7f3f7b
.long 0xbf7bbf80, 0xbf55bf6d, 0xbf0ebf35, 0xbe48bec4, 0x3ef13f35, 0xbdc93e48, 0xbf22bec4, 0xbf75bf55
.long 0x3ec48000, 0x3f6d3f35, 0x3f6d3f80, 0x3ec43f35, 0xbf75bf35, 0xbf46bf7b, 0x3dc9bec4, 0x3f623f0e
.long 0x3f553f80, 0xbe483ec4, 0xbf7bbf35, 0xbf0ebf6d, 0xbdc9bf35, 0x3f753f0e, 0x3ef13f6d, 0xbf46be48
.long 0xbf350000, 0xbf35bf80, 0x3f358000, 0x3f353f80, 0x3f7f3f35, 0xbe953f0e, 0xbf62bf6d, 0x3f22be48
.long 0xbf0ebf80, 0x3f7b3ec4, 0xbe483f35, 0xbf55bf6d, 0xbe953f35, 0xbf22bf7b, 0x3f7f3ec4, 0xbef13f0e
.long 0x3f6d8000, 0xbec43f35, 0xbec4bf80, 0x3f6d3f35, 0xbf62bf35, 0x3f7f3e48, 0xbf463ec4, 0x3e95bf55
.long 0x3e483f80, 0xbf0ebf6d, 0x3f553f35, 0xbf7bbec4, 0x3f22bf35, 0xbef13f55, 0x3e95bf6d, 0xbdc93f7b
.long 0xbf803f80, 0xbf803f80, 0xbf803f80, 0xbf803f80, 0x3f7f3f80, 0x3f753f7b, 0x3f623f6d, 0x3f463f55
.long 0x3e488000, 0x3f0e3ec4, 0x3f553f35, 0x3f7b3f6d, 0xbf75bf80, 0xbf22bf55, 0xbdc9bec4, 0x3ef13e48
.long 0xbec40000, 0xbf6dbf35, 0xbf6dbf80, 0xbec4bf35, 0x3f623f80, 0x3dc93f0e, 0xbf46bec4, 0xbf75bf7b
.long 0x3f0e8000, 0x3f7b3f6d, 0x3e483f35, 0xbf55bec4, 0xbf46bf80, 0x3ef1be48, 0x3f753f6d, 0xbdc93f0e
.long 0xbf350000, 0xbf35bf80, 0x3f358000, 0x3f353f80, 0x3f223f80, 0xbf62be48, 0xbe95bf6d, 0x3f7f3f0e
.long 0x3f558000, 0x3e483f6d, 0xbf7bbf35, 0x3f0ebec4, 0xbef1bf80, 0x3f7f3f0e, 0xbf223ec4, 0xbe95bf7b
.long 0xbf6d0000, 0x3ec4bf35, 0x3ec43f80, 0xbf6dbf35, 0x3e953f80, 0xbf46bf55, 0x3f7f3ec4, 0xbf623e48
.long 0x3f7b8000, 0xbf553ec4, 0x3f0ebf35, 0xbe483f6d, 0xbdc9bf80, 0x3e953f7b, 0xbef1bf6d, 0x3f223f55
.long 0xbf803f80, 0xbf803f80, 0xbf803f80, 0xbf803f80, 0x3f223f35, 0x3ef13f0e, 0x3e953ec4, 0x3dc93e48
.long 0x3f7b3f80, 0x3f553f6d, 0x3f0e3f35, 0x3e483ec4, 0x3f623f35, 0x3f7f3f7b, 0x3f463f6d, 0x3e953f0e
.long 0x3ec48000, 0x3f6d3f35, 0x3f6d3f80, 0x3ec43f35, 0xbe95bf35, 0x3f223e48, 0x3f7f3f6d, 0x3ef13f55
.long 0xbf55bf80, 0x3e48bec4, 0x3f7b3f35, 0x3f0e3f6d, 0xbf7fbf35, 0xbe95bf55, 0x3f623ec4, 0x3f223f7b
.long 0xbf350000, 0xbf35bf80, 0x3f358000, 0x3f353f80, 0xbdc93f35, 0xbf75bf55, 0x3ef1bec4, 0x3f463f7b
.long 0x3f0e3f80, 0xbf7bbec4, 0x3e48bf35, 0x3f553f6d, 0x3f753f35, 0xbf463e48, 0xbdc9bf6d, 0x3f623f55
.long 0x3f6d8000, 0xbec43f35, 0xbec4bf80, 0x3f6d3f35, 0x3ef1bf35, 0x3dc93f7b, 0xbf22bf6d, 0x3f753f0e
.long 0xbe48bf80, 0x3f0e3f6d, 0xbf55bf35, 0x3f7b3ec4, 0xbf46bf35, 0x3f623f0e, 0xbf75bec4, 0x3f7f3e48
.long 0xbf800000, 0x3f808000, 0xbf800000, 0x3f808000, 0xbf7f0000, 0x3f753e48, 0xbf62bec4, 0x3f463f0e
.long 0xbf7b0000, 0x3f553ec4, 0xbf0ebf35, 0x3e483f6d, 0xbf750000, 0x3f223f0e, 0xbdc9bf6d, 0xbef13f7b
.long 0xbf6d0000, 0x3ec43f35, 0x3ec4bf80, 0xbf6d3f35, 0xbf620000, 0x3dc93f55, 0x3f46bf6d, 0xbf753e48
.long 0xbf550000, 0xbe483f6d, 0x3f7bbf35, 0xbf0ebec4, 0xbf460000, 0xbef13f7b, 0x3f75bec4, 0x3dc9bf55
.long 0xbf350000, 0xbf353f80, 0x3f358000, 0x3f35bf80, 0xbf220000, 0xbf623f7b, 0x3e953ec4, 0x3f7fbf55
.long 0xbf0e0000, 0xbf7b3f6d, 0xbe483f35, 0x3f55bec4, 0xbef10000, 0xbf7f3f55, 0xbf223f6d, 0x3e953e48
.long 0xbec40000, 0xbf6d3f35, 0xbf6d3f80, 0xbec43f35, 0xbe950000, 0xbf463f0e, 0xbf7f3f6d, 0xbf623f7b
.long 0xbe480000, 0xbf0e3ec4, 0xbf553f35, 0xbf7b3f6d, 0xbdc90000, 0xbe953e48, 0xbef13ec4, 0xbf223f0e
.long 0xbf800000, 0x3f808000, 0xbf800000, 0x3f808000, 0xbf22bf35, 0x3ef13f55, 0xbe95bf6d, 0x3dc93f7b
.long 0x3e48bf80, 0xbf0e3f6d, 0x3f55bf35, 0xbf7b3ec4, 0x3f62bf35, 0xbf7f3e48, 0x3f463ec4, 0xbe95bf55
.long 0x3f6d8000, 0xbec4bf35, 0xbec43f80, 0x3f6dbf35, 0x3e953f35, 0x3f22bf7b, 0xbf7f3ec4, 0x3ef13f0e
.long 0xbf0e3f80, 0x3f7bbec4, 0xbe48bf35, 0xbf553f6d, 0xbf7f3f35, 0x3e953f0e, 0x3f62bf6d, 0xbf22be48
.long 0xbf350000, 0xbf353f80, 0x3f358000, 0x3f35bf80, 0x3dc9bf35, 0xbf753f0e, 0xbef13f6d, 0x3f46be48
.long 0x3f55bf80, 0xbe48bec4, 0xbf7b3f35, 0xbf0e3f6d, 0x3f75bf35, 0x3f46bf7b, 0xbdc9bec4, 0xbf623f0e
.long 0x3ec48000, 0x3f6dbf35, 0x3f6dbf80, 0x3ec4bf35, 0xbef13f35, 0x3dc93e48, 0x3f22bec4, 0x3f75bf55
.long 0xbf7b3f80, 0xbf553f6d, 0xbf0e3f35, 0xbe483ec4, 0xbf463f35, 0xbf623f55, 0xbf753f6d, 0xbf7f3f7b
.long 0xbf800000, 0x3f808000, 0xbf800000, 0x3f808000, 0x3dc9bf80, 0xbe953f7b, 0x3ef1bf6d, 0xbf223f55
.long 0x3f7b8000, 0xbf55bec4, 0x3f0e3f35, 0xbe48bf6d, 0xbe953f80, 0x3f46bf55, 0xbf7f3ec4, 0x3f623e48
.long 0xbf6d0000, 0x3ec43f35, 0x3ec4bf80, 0xbf6d3f35, 0x3ef1bf80, 0xbf7f3f0e, 0x3f223ec4, 0x3e95bf7b
.long 0x3f558000, 0x3e48bf6d, 0xbf7b3f35, 0x3f0e3ec4, 0xbf223f80, 0x3f62be48, 0x3e95bf6d, 0xbf7f3f0e
.long 0xbf350000, 0xbf353f80, 0x3f358000, 0x3f35bf80, 0x3f46bf80, 0xbef1be48, 0xbf753f6d, 0x3dc93f0e
.long 0x3f0e8000, 0x3f7bbf6d, 0x3e48bf35, 0xbf553ec4, 0xbf623f80, 0xbdc93f0e, 0x3f46bec4, 0x3f75bf7b
.long 0xbec40000, 0xbf6d3f35, 0xbf6d3f80, 0xbec43f35, 0x3f75bf80, 0x3f22bf55, 0x3dc9bec4, 0xbef13e48
.long 0x3e488000, 0x3f0ebec4, 0x3f55bf35, 0x3f7bbf6d, 0xbf7f3f80, 0xbf753f7b, 0xbf623f6d, 0xbf463f55
.long 0xbf800000, 0x3f808000, 0xbf800000, 0x3f808000, 0x3f46bf35, 0xbf623f0e, 0x3f75bec4, 0xbf7f3e48
.long 0xbe483f80, 0x3f0ebf6d, 0xbf553f35, 0x3f7bbec4, 0xbef1bf35, 0xbdc93f7b, 0x3f22bf6d, 0xbf753f0e
.long 0x3f6d8000, 0xbec4bf35, 0xbec43f80, 0x3f6dbf35, 0xbf753f35, 0x3f463e48, 0x3dc9bf6d, 0xbf623f55
.long 0x3f0ebf80, 0xbf7b3ec4, 0x3e483f35, 0x3f55bf6d, 0x3dc93f35, 0x3f75bf55, 0xbef1bec4, 0xbf463f7b
.long 0xbf350000, 0xbf353f80, 0x3f358000, 0x3f35bf80, 0x3f7fbf35, 0x3e95bf55, 0xbf623ec4, 0xbf223f7b
.long 0xbf553f80, 0x3e483ec4, 0x3f7bbf35, 0x3f0ebf6d, 0x3e95bf35, 0xbf223e48, 0xbf7f3f6d, 0xbef13f55
.long 0x3ec48000, 0x3f6dbf35, 0x3f6dbf80, 0x3ec4bf35, 0xbf623f35, 0xbf7f3f7b, 0xbf463f6d, 0xbe953f0e
.long 0x3f7bbf80, 0x3f55bf6d, 0x3f0ebf35, 0x3e48bec4, 0xbf223f35, 0xbef13f0e, 0xbe953ec4, 0xbdc93e48
.long 0xbf800000, 0x3f808000, 0xbf800000, 0x3f808000, 0x3f7f8000, 0xbf75be48, 0x3f623ec4, 0xbf46bf0e
.long 0xbf7b0000, 0x3f553ec4, 0xbf0ebf35, 0x3e483f6d, 0x3f758000, 0xbf22bf0e, 0x3dc93f6d, 0x3ef1bf7b
.long 0xbf6d0000, 0x3ec43f35, 0x3ec4bf80, 0xbf6d3f35, 0x3f628000, 0xbdc9bf55, 0xbf463f6d, 0x3f75be48
.long 0xbf550000, 0xbe483f6d, 0x3f7bbf35, 0xbf0ebec4, 0x3f468000, 0x3ef1bf7b, 0xbf753ec4, 0xbdc93f55
.long 0xbf350000, 0xbf353f80, 0x3f358000, 0x3f35bf80, 0x3f228000, 0x3f62bf7b, 0xbe95bec4, 0xbf7f3f55
.long 0xbf0e0000, 0xbf7b3f6d, 0xbe483f35, 0x3f55bec4, 0x3ef18000, 0x3f7fbf55, 0x3f22bf6d, 0xbe95be48
.long 0xbec40000, 0xbf6d3f35, 0xbf6d3f80, 0xbec43f35, 0x3e958000, 0x3f46bf0e, 0x3f7fbf6d, 0x3f62bf7b
.long 0xbe480000, 0xbf0e3ec4, 0xbf553f35, 0xbf7b3f6d, 0x3dc98000, 0x3e95be48, 0x3ef1bec4, 0x3f22bf0e
.long 0xbf800000, 0x3f808000, 0xbf800000, 0x3f808000, 0x3f223f35, 0xbef1bf55, 0x3e953f6d, 0xbdc9bf7b
.long 0x3e48bf80, 0xbf0e3f6d, 0x3f55bf35, 0xbf7b3ec4, 0xbf623f35, 0x3f7fbe48, 0xbf46bec4, 0x3e953f55
.long 0x3f6d8000, 0xbec4bf35, 0xbec43f80, 0x3f6dbf35, 0xbe95bf35, 0xbf223f7b, 0x3f7fbec4, 0xbef1bf0e
.long 0xbf0e3f80, 0x3f7bbec4, 0xbe48bf35, 0xbf553f6d, 0x3f7fbf35, 0xbe95bf0e, 0xbf623f6d, 0x3f223e48
.long 0xbf350000, 0xbf353f80, 0x3f358000, 0x3f35bf80, 0xbdc93f35, 0x3f75bf0e, 0x3ef1bf6d, 0xbf463e48
.long 0x3f55bf80, 0xbe48bec4, 0xbf7b3f35, 0xbf0e3f6d, 0xbf753f35, 0xbf463f7b, 0x3dc93ec4, 0x3f62bf0e
.long 0x3ec48000, 0x3f6dbf35, 0x3f6dbf80, 0x3ec4bf35, 0x3ef1bf35, 0xbdc9be48, 0xbf223ec4, 0xbf753f55
.long 0xbf7b3f80, 0xbf553f6d, 0xbf0e3f35, 0xbe483ec4, 0x3f46bf35, 0x3f62bf55, 0x3f75bf6d, 0x3f7fbf7b
.long 0xbf800000, 0x3f808000, 0xbf800000, 0x3f808000, 0xbdc93f80, 0x3e95bf7b, 0xbef13f6d, 0x3f22bf55
.long 0x3f7b8000, 0xbf55bec4, 0x3f0e3f35, 0xbe48bf6d, 0x3e95bf80, 0xbf463f55, 0x3f7fbec4, 0xbf62be48
.long 0xbf6d0000, 0x3ec43f35, 0x3ec4bf80, 0xbf6d3f35, 0xbef13f80, 0x3f7fbf0e, 0xbf22bec4, 0xbe953f7b
.long 0x3f558000, 0x3e48bf6d, 0xbf7b3f35, 0x3f0e3ec4, 0x3f22bf80, 0xbf623e48, 0xbe953f6d, 0x3f7fbf0e
.long 0xbf350000, 0xbf353f80, 0x3f358000, 0x3f35bf80, 0xbf463f80, 0x3ef13e48, 0x3f75bf6d, 0xbdc9bf0e
.long 0x3f0e8000, 0x3f7bbf6d, 0x3e48bf35, 0xbf553ec4, 0x3f62bf80, 0x3dc9bf0e, 0xbf463ec4, 0xbf753f7b
.long 0xbec40000, 0xbf6d3f35, 0xbf6d3f80, 0xbec43f35, 0xbf753f80, 0xbf223f55, 0xbdc93ec4, 0x3ef1be48
.long 0x3e488000, 0x3f0ebec4, 0x3f55bf35, 0x3f7bbf6d, 0x3f7fbf80, 0x3f75bf7b, 0x3f62bf6d, 0x3f46bf55
.long 0xbf800000, 0x3f808000, 0xbf800000, 0x3f808000, 0xbf463f35, 0x3f62bf0e, 0xbf753ec4, 0x3f7fbe48
.long 0xbe483f80, 0x3f0ebf6d, 0xbf553f35, 0x3f7bbec4, 0x3ef13f35, 0x3dc9bf7b, 0xbf223f6d, 0x3f75bf0e
.long 0x3f6d8000, 0xbec4bf35, 0xbec43f80, 0x3f6dbf35, 0x3f75bf35, 0xbf46be48, 0xbdc93f6d, 0x3f62bf55
.long 0x3f0ebf80, 0xbf7b3ec4, 0x3e483f35, 0x3f55bf6d, 0xbdc9bf35, 0xbf753f55, 0x3ef13ec4, 0x3f46bf7b
.long 0xbf350000, 0xbf353f80, 0x3f358000, 0x3f35bf80, 0xbf7f3f35, 0xbe953f55, 0x3f62bec4, 0x3f22bf7b
.long 0xbf553f80, 0x3e483ec4, 0x3f7bbf35, 0x3f0ebf6d, 0xbe953f35, 0x3f22be48, 0x3f7fbf6d, 0x3ef1bf55
.long 0x3ec48000, 0x3f6dbf35, 0x3f6dbf80, 0x3ec4bf35, 0x3f62bf35, 0x3f7fbf7b, 0x3f46bf6d, 0x3e95bf0e
.long 0x3f7bbf80, 0x3f55bf6d, 0x3f0ebf35, 0x3e48bec4, 0x3f22bf35, 0x3ef1bf0e, 0x3e95bec4, 0x3dc9be48
.long 0x00000000, 0x00000000, 0xa6ea0000, 0xa6800000, 0x00000000, 0x00000000, 0x00000000, 0xa6000000
.long 0x00000000, 0x00000000, 0x00000000, 0x00000000, 0x00000000, 0x00000000, 0x00000000, 0x00000000
.long 0xa7000000, 0xa6000000, 0xa6e00000, 0xa777a000, 0x00000000, 0x00000000, 0x00000000, 0xa5800000
.long 0x00000000, 0xa7400000, 0x00000000, 0x00000000, 0x00000000, 0x00000000, 0x00000000, 0x00000000
.long 0x28f6c000, 0x00000000, 0xa7400000, 0x00000000, 0x00000000, 0x00000000, 0x00000000, 0x00000000
.long 0x00000000, 0x00000000, 0x00000000, 0x00000000, 0x00000000, 0x00000000, 0x00000000, 0x00000000
.long 0x00000000, 0xa6800000, 0xa7000000, 0xa777a000, 0x00000000, 0x00000000, 0x00000000, 0x00000000
.long 0x00000000, 0x00000000, 0x00000000, 0x00000000, 0x00000000, 0x00000000, 0x00000000, 0x00000000
.long 0x00000000, 0xa6800000, 0xa6dcc000, 0x00000000, 0xa5800000, 0xa5800000, 0x00000000, 0x00000000
.long 0x00000000, 0x00000000, 0x00000000, 0x00000000, 0xa6800000, 0x00000000, 0x00000000, 0x00000000
.long 0xa7000000, 0xa6000000, 0xa8000000, 0x00000000, 0xa5800000, 0x00000000, 0x00000000, 0x00000000
.long 0x00000000, 0x00000000, 0x00000000, 0x00000000, 0x00000000, 0x00000000, 0x00000000, 0x00000000
.long 0xa7d28000, 0x00000000, 0xa7800000, 0x00000000, 0x00000000, 0x00000000, 0x00000000, 0x00000000
.long 0x00000000, 0x00000000, 0x00000000, 0x00000000, 0xa6800000, 0x00000000, 0x00000000, 0x00000000
.long 0xa6800000, 0xa6800000, 0x00000000, 0x00000000, 0x00000000, 0x00000000, 0x00000000, 0x00000000
.long 0xa7400000, 0x00000000, 0x00000000, 0x00000000, 0x00000000, 0x00000000, 0x00000000, 0x00000000
.long 0x00000000, 0xa6000000, 0xa7750000, 0xa777a000, 0x00000000, 0x00000000, 0xa5800000, 0xa5800000
.long 0x00000000, 0xa7400000, 0xa6000000, 0xa6000000, 0xa5800000, 0xa5800000, 0xa5800000, 0xa5800000
.long 0xa7000000, 0xa6800000, 0xa6e00000, 0xa6800000, 0xa5800000, 0xa6800000, 0xa5800000, 0xa5800000
.long 0xa6000000, 0xa6000000, 0xa6000000, 0xa6000000, 0xa5800000, 0xa5800000, 0xa6800000, 0xa5800000
.long 0x26468000, 0xa6800000, 0xa7300000, 0xa777a000, 0x00000000, 0x00000000, 0xa5800000, 0xa5800000
.long 0x00000000, 0xa6800000, 0xa6000000, 0xa6000000, 0xa5800000, 0xa5800000, 0xa5800000, 0xa5800000
.long 0xa6800000, 0x00000000, 0xa7000000, 0x00000000, 0xa5800000, 0xa6800000, 0xa5800000, 0xa5800000
.long 0xa6000000, 0xa6000000, 0xa6000000, 0xa6000000, 0xa5800000, 0xa5800000, 0xa6800000, 0xa5800000
.long 0x00000000, 0xa6000000, 0xa8800000, 0x00000000, 0xa5800000, 0xa5800000, 0x00000000, 0x00000000
.long 0xa6800000, 0x00000000, 0x00000000, 0x00000000, 0xa5800000, 0xa5800000, 0x00000000, 0x00000000
.long 0xa7000000, 0x00000000, 0xa6c00000, 0xa6000000, 0xa6000000, 0x00000000, 0xa5800000, 0xa5800000
.long 0x00000000, 0x00000000, 0xa6000000, 0xa7300000, 0x00000000, 0x00000000, 0xa5800000, 0xa5800000
.long 0xa7ca8000, 0xa6800000, 0xa8800000, 0x00000000, 0xa5800000, 0xa5800000, 0x00000000, 0x00000000
.long 0xa7400000, 0xa6000000, 0x00000000, 0x00000000, 0xa5800000, 0xa5800000, 0x00000000, 0x00000000
.long 0x00000000, 0x00000000, 0x00000000, 0xa6800000, 0xa6000000, 0x00000000, 0xa5800000, 0xa5800000
.long 0x00000000, 0x00000000, 0x00000000, 0xa6800000, 0x00000000, 0x00000000, 0xa5800000, 0xa5800000
.long 0x00000000, 0xa6800000, 0xa7750000, 0xa6800000, 0xa5800000, 0xa6800000, 0xa5800000, 0xa5800000
.long 0xa6000000, 0xa6000000, 0xa6000000, 0xa6000000, 0xa5000000, 0xa5000000, 0xa6800000, 0xa5000000
.long 0xa6e00000, 0xa777a000, 0xa6c00000, 0xa6000000, 0xa5800000, 0xa5800000, 0xa5800000, 0xa5800000
.long 0xa6000000, 0xa5800000, 0xa6800000, 0xa6000000, 0xa5800000, 0xa5800000, 0xa5800000, 0xa5800000
.long 0x27a8d000, 0x00000000, 0xa7300000, 0x00000000, 0xa5000000, 0xa6800000, 0xa5000000, 0xa5000000
.long 0xa6000000, 0xa6000000, 0xa5800000, 0xa5800000, 0xa5000000, 0xa5000000, 0xa6800000, 0xa5000000
.long 0xa7000000, 0xa777a000, 0xa6800000, 0xa6800000, 0xa5800000, 0xa5800000, 0xa5800000, 0xa5800000
.long 0xa6000000, 0xa6000000, 0xa7300000, 0xa6000000, 0xa5800000, 0xa5800000, 0xa5800000, 0xa5800000
.long 0x00000000, 0x00000000, 0xa6dcc000, 0xa6000000, 0xa6000000, 0x00000000, 0xa5800000, 0xa5800000
.long 0x00000000, 0x00000000, 0xa6000000, 0xa7300000, 0x00000000, 0x00000000, 0xa5800000, 0xa5800000
.long 0xa8000000, 0x00000000, 0xa6c00000, 0xa6800000, 0x00000000, 0x00000000, 0xa5800000, 0xa6800000
.long 0x00000000, 0x00000000, 0xa6000000, 0xa6000000, 0x00000000, 0xa6000000, 0xa5000000, 0xa5000000
.long 0xa78a8000, 0x00000000, 0xa7800000, 0xa6800000, 0xa6000000, 0x00000000, 0xa5800000, 0xa5800000
.long 0x00000000, 0x00000000, 0xa6000000, 0xa6800000, 0x00000000, 0x00000000, 0xa5800000, 0xa5800000
.long 0xa8000000, 0x00000000, 0xa6800000, 0x00000000, 0x00000000, 0x00000000, 0xa5000000, 0xa6800000
.long 0x00000000, 0x00000000, 0xa6000000, 0xa5800000, 0x00000000, 0xa6000000, 0xa5000000, 0xa5000000
.long 0x00000000, 0xa777a000, 0xa6ea0000, 0xa6000000, 0xa5800000, 0xa5800000, 0xa5800000, 0xa5800000
.long 0xa6000000, 0xa5800000, 0xa6800000, 0xa6000000, 0xa5800000, 0xa5800000, 0xa5800000, 0xa5800000
.long 0xa6e00000, 0xa6800000, 0xa6c00000, 0x00000000, 0xa5800000, 0xa5800000, 0xa6000000, 0x00000000
.long 0xa6000000, 0xa5800000, 0x00000000, 0x00000000, 0xa6800000, 0xa5000000, 0x00000000, 0x00000000
.long 0x26c34000, 0xa777a000, 0xa7400000, 0xa6800000, 0xa5800000, 0xa5800000, 0xa5800000, 0xa5800000
.long 0xa6000000, 0xa6000000, 0xa7300000, 0xa6000000, 0xa5800000, 0xa5800000, 0xa5800000, 0xa5800000
.long 0xa7000000, 0x00000000, 0x00000000, 0x00000000, 0xa5000000, 0xa5000000, 0xa6000000, 0x00000000
.long 0xa5800000, 0xa5800000, 0x00000000, 0x00000000, 0xa6800000, 0xa5000000, 0x00000000, 0x00000000
.size fnet_tables, 9984
L_code_end:
.section .rodata,"a"
.p2align 6
.amdhsa_kernel sequential_preLN__spectral_fnet__moe_arch_mod__prompt_kernel
  .amdhsa_next_free_vgpr 232
  .amdhsa_next_free_sgpr 96
  .amdhsa_accum_offset 232
  .amdhsa_group_segment_fixed_size 0
  .amdhsa_kernarg_size 104
  .amdhsa_user_sgpr_count 2
  .amdhsa_user_sgpr_kernarg_segment_ptr 1
  .amdhsa_system_sgpr_workgroup_id_x 1
.end_amdhsa_kernel
```
